```python
import torch

def _softmax(x, axis=-1):
    return torch.softmax(x, dim=axis)
def _gelu(x):
    return torch.nn.functional.gelu(x, approximate="tanh")
def _silu(x):
    return torch.nn.functional.silu(x)
def _sigmoid(x):
    return torch.sigmoid(x)
def _layernorm(x, axis=-1, eps=1e-5):
    m = x.mean(dim=axis, keepdim=True)
    v = x.var(dim=axis, keepdim=True, unbiased=False)
    return (x - m) / torch.sqrt(v + eps)
def _scatter_add(tgt, idx, src, axis=0):
    return tgt.clone().index_add_(axis, idx, src)
def _segment_sum(src, seg, n):
    out = torch.zeros((n,) + src.shape[1:], dtype=src.dtype)
    return out.index_add_(0, seg, src)
def _pad(x, pw):
    flat = tuple(v for pair in reversed(pw) for v in pair)
    return torch.nn.functional.pad(x, flat)

kernel_name = 'standalone__gqa_block_cached__sampling'

def setup_inputs():

    _w = (lambda a: (lambda t: t.to(torch.bfloat16) if t.is_floating_point() else t)(torch.as_tensor(a)))
    B, Sq, D = 8, 4, 1024
    Hq, Hkv, Sk, Dh = 32, 4, 8192, 128
    assert Hq % Hkv == 0, (Hq, Hkv)
    return {
        "x": _w((lambda *s: torch.randn(*s, dtype=torch.bfloat16) * 0.8)(B, Sq, D)),
        "k_cache": _w((lambda *s: torch.randn(*s, dtype=torch.bfloat16) * 0.8)(B, Hkv, Sk, Dh)),
        "v_cache": _w((lambda *s: torch.randn(*s, dtype=torch.bfloat16) * 0.05)(B, Hkv, Sk, Dh)),
        "wq": _w((lambda *s: torch.randn(*s, dtype=torch.bfloat16) * 0.8)(D, Hq * Dh) * (D ** -0.5)),
        "wo": _w((lambda *s: torch.randn(*s, dtype=torch.bfloat16) * 0.05)(Hq * Dh, D) * ((Hq * Dh) ** -0.5)),
    }

def reference(x, k_cache, v_cache, wq, wo):
    B, Sq, D = x.shape
    Hq, Dh = 32, 128
    Hkv = k_cache.shape[1]
    rep = Hq // Hkv
    q = (lambda x, *d: x.permute(*d))((x @ wq).reshape(B, Sq, Hq, Dh), 0, 2, 1, 3)
    k = (lambda x, n, axis: torch.repeat_interleave(x, n, dim=axis))(k_cache, rep, axis=1)
    v = (lambda x, n, axis: torch.repeat_interleave(x, n, dim=axis))(v_cache, rep, axis=1)
    scores = torch.einsum("bhqd,bhkd->bhqk", q, k) * (Dh ** -0.5)
    p = _softmax(scores, axis=-1)
    o = torch.einsum("bhqk,bhkd->bhqd", p, v)
    return (lambda x, *d: x.permute(*d))(o, 0, 2, 1, 3).reshape(B, Sq, Hq * Dh) @ wo
```

```asm
; @launch grid=(256,1,1) block=(512,1,1) lds=163840
.amdgcn_target "amdgcn-amd-amdhsa--gfx950"
.text
.globl standalone__gqa_block_cached__sampling_kernel
.p2align 8
.type standalone__gqa_block_cached__sampling_kernel,@function
standalone__gqa_block_cached__sampling_kernel:
    s_load_dwordx16 s[60:75], s[0:1], 0
    s_cmp_ge_u32 s2, 256
    s_cbranch_scc1 L_end
    v_lshrrev_b32 v1, 6, v0
    v_and_b32 v0, 63, v0
    v_readfirstlane_b32 s3, v1
    s_and_b32 s4, s2, 7
    s_lshl_b32 s4, s4, 5
    s_lshr_b32 s7, s2, 3
    s_add_u32 s4, s4, s7
    v_lshrrev_b32 v1, 4, v0
    v_and_b32 v2, 15, v0
    v_mov_b32 v7, 0x26600
    s_mov_b32 s45, 0
    s_cmp_eq_u32 s3, 0
    s_cbranch_scc1 L_L
    s_cmp_lt_u32 s3, 4
    s_cbranch_scc1 L_nopf
    s_cmp_ge_u32 s2, 16
    s_cbranch_scc1 L_nopf
    s_getpc_b64 s[46:47]
L_pc:
    s_sub_u32 s46, s46, L_pc-standalone__gqa_block_cached__sampling_kernel
    s_subb_u32 s47, s47, 0
    s_sub_u32 s7, s3, 4
    s_lshl_b32 s7, s7, 13
    v_lshlrev_b32 v3, 7, v0
    v_add_u32 v3, s7, v3
    v_min_u32 v3, L_end-standalone__gqa_block_cached__sampling_kernel, v3
    global_load_dword v4, v3, s[46:47]
L_nopf:
    s_cmp_lg_u32 s3, 3
    s_cbranch_scc1 L_noinit
    v_mov_b32 v9, 0
    v_lshl_add_u32 v8, v0, 2, v7
    ds_write_b32 v8, v9
    s_waitcnt lgkmcnt(0)
L_noinit:
    s_barrier
    s_branch L_notL
L_L:
    s_setprio 3
    v_lshrrev_b32 v10, 3, v0
    v_and_b32 v11, 7, v0
    v_lshlrev_b32 v11, 7, v11
    v_lshl_add_u32 v10, v10, 13, v11
    s_and_b32 s36, s4, 31
    s_lshl_b32 s36, s36, 18
    s_lshr_b32 s7, s4, 5
    s_lshl_b32 s7, s7, 10
    s_add_u32 s36, s36, s7
    s_mov_b32 s18, 0x800000
    s_mov_b32 s19, 0x20000
    s_waitcnt lgkmcnt(0)
    s_mov_b32 s16, s66
    s_mov_b32 s17, s67
    buffer_load_dword v20, v10, s[16:19], s36 offen
    s_add_u32 s36, s36, 0x10000
    buffer_load_dword v21, v10, s[16:19], s36 offen
    s_add_u32 s36, s36, 0x10000
    buffer_load_dword v22, v10, s[16:19], s36 offen
    s_add_u32 s36, s36, 0x10000
    buffer_load_dword v23, v10, s[16:19], s36 offen
    s_memrealtime s[48:49]
    s_barrier
    s_mov_b32 s8, s62
    s_mov_b32 s9, s63
    s_mov_b32 s10, 0x4000000
    s_mov_b32 s11, 0x20000
    v_xor_b32 v3, v1, v2
    v_lshlrev_b32 v3, 4, v3
    v_lshl_add_u32 v3, v1, 8, v3
    v_xor_b32 v4, 64, v3
    v_xor_b32 v5, 0x80, v3
    v_xor_b32 v6, 0xc0, v3
    s_lshl_b32 s39, s4, 18
    s_mov_b32 s37, s39
    s_mov_b32 s55, 2
    s_mov_b32 s56, 0
    s_waitcnt lgkmcnt(0)
    s_add_u32 s43, s48, 290
    s_mov_b32 m0, 0
    s_waitcnt vmcnt(2)
    buffer_load_dwordx4 v3, s[8:11], s37 offen offset:0 nt lds
    buffer_load_dwordx4 v4, s[8:11], s37 offen offset:1024 nt lds
    buffer_load_dwordx4 v5, s[8:11], s37 offen offset:2048 nt lds
    buffer_load_dwordx4 v6, s[8:11], s37 offen offset:3072 nt lds
    s_mov_b32 m0, 4096
    s_add_u32 s37, s37, 4096
    buffer_load_dwordx4 v3, s[8:11], s37 offen offset:0 nt lds
    buffer_load_dwordx4 v4, s[8:11], s37 offen offset:1024 nt lds
    buffer_load_dwordx4 v5, s[8:11], s37 offen offset:2048 nt lds
    buffer_load_dwordx4 v6, s[8:11], s37 offen offset:3072 nt lds
    s_add_u32 s37, s37, 4096
    s_mov_b32 m0, 24576
    s_waitcnt vmcnt(9)
    buffer_load_dwordx4 v3, s[8:11], s37 offen offset:0 nt lds
    buffer_load_dwordx4 v4, s[8:11], s37 offen offset:1024 nt lds
    buffer_load_dwordx4 v5, s[8:11], s37 offen offset:2048 nt lds
    buffer_load_dwordx4 v6, s[8:11], s37 offen offset:3072 nt lds
    s_mov_b32 m0, 28672
    s_add_u32 s37, s37, 4096
    buffer_load_dwordx4 v3, s[8:11], s37 offen offset:0 nt lds
    buffer_load_dwordx4 v4, s[8:11], s37 offen offset:1024 nt lds
    buffer_load_dwordx4 v5, s[8:11], s37 offen offset:2048 nt lds
    buffer_load_dwordx4 v6, s[8:11], s37 offen offset:3072 nt lds
    s_add_u32 s37, s37, 4096
    v_mov_b32 v8, 1
    s_waitcnt vmcnt(16)
    ds_write_b32 v7, v8 offset:44
L_loop:
    s_and_b32 s7, s55, 3
    s_mul_i32 s38, s7, 24576
    s_add_u32 s38, s38, s56
    s_waitcnt lgkmcnt(0)
    s_cmp_lt_u32 s55, 12
    s_cbranch_scc1 L_go
    s_lshr_b32 s57, s55, 2
    s_sub_u32 s57, s57, 2
    v_readfirstlane_b32 s36, v9
    s_cmp_lt_u32 s36, s57
    s_cbranch_scc1 L_full
L_go:
    s_mul_i32 s7, s45, 27
    s_sub_u32 s7, s48, s7
    s_sub_u32 s7, s7, s43
    s_cmp_gt_i32 s7, 50
    s_cbranch_scc1 L_lv2
    s_cmp_gt_i32 s7, 0
    s_cbranch_scc1 L_lv1
    s_mov_b32 m0, s38
    s_waitcnt vmcnt(20)
    buffer_load_dwordx4 v3, s[8:11], s37 offen offset:0 nt lds
    s_waitcnt vmcnt(20)
    buffer_load_dwordx4 v4, s[8:11], s37 offen offset:1024 nt lds
    s_add_u32 s7, s55, 1
    s_and_b32 s7, s7, 3
    s_lshl_b32 s7, s7, 2
    v_add_u32 v10, s7, v7
    s_waitcnt vmcnt(20)
    buffer_load_dwordx4 v5, s[8:11], s37 offen offset:2048 nt lds
    s_waitcnt vmcnt(20)
    buffer_load_dwordx4 v6, s[8:11], s37 offen offset:3072 nt lds
    s_add_u32 m0, s38, 4096
    s_add_u32 s37, s37, 4096
    s_waitcnt vmcnt(20)
    buffer_load_dwordx4 v3, s[8:11], s37 offen offset:0 nt lds
    s_sub_i32 s7, s55, 2
    s_max_i32 s45, s45, s7
    v_mov_b32 v8, s45
    ds_write_b32 v7, v8
    s_memrealtime s[48:49]
    s_waitcnt vmcnt(20)
    buffer_load_dwordx4 v4, s[8:11], s37 offen offset:1024 nt lds
    s_waitcnt vmcnt(20)
    buffer_load_dwordx4 v5, s[8:11], s37 offen offset:2048 nt lds
    ds_read_b32 v9, v10 offset:16
    s_waitcnt vmcnt(20)
    buffer_load_dwordx4 v6, s[8:11], s37 offen offset:3072 nt lds
    s_branch L_next
L_lv1:
    s_mov_b32 m0, s38
    s_waitcnt vmcnt(24)
    buffer_load_dwordx4 v3, s[8:11], s37 offen offset:0 nt lds
    s_sub_i32 s7, s55, 3
    s_max_i32 s45, s45, s7
    v_mov_b32 v8, s45
    ds_write_b32 v7, v8
    s_memrealtime s[48:49]
    s_waitcnt vmcnt(24)
    buffer_load_dwordx4 v4, s[8:11], s37 offen offset:1024 nt lds
    s_add_u32 s7, s55, 1
    s_and_b32 s7, s7, 3
    s_lshl_b32 s7, s7, 2
    v_add_u32 v10, s7, v7
    s_waitcnt vmcnt(24)
    buffer_load_dwordx4 v5, s[8:11], s37 offen offset:2048 nt lds
    s_waitcnt vmcnt(24)
    buffer_load_dwordx4 v6, s[8:11], s37 offen offset:3072 nt lds
    s_add_u32 m0, s38, 4096
    s_add_u32 s37, s37, 4096
    s_waitcnt vmcnt(24)
    buffer_load_dwordx4 v3, s[8:11], s37 offen offset:0 nt lds
    s_waitcnt vmcnt(24)
    buffer_load_dwordx4 v4, s[8:11], s37 offen offset:1024 nt lds
    s_waitcnt vmcnt(24)
    buffer_load_dwordx4 v5, s[8:11], s37 offen offset:2048 nt lds
    ds_read_b32 v9, v10 offset:16
    s_waitcnt vmcnt(24)
    buffer_load_dwordx4 v6, s[8:11], s37 offen offset:3072 nt lds
    s_branch L_next
L_lv2:
    s_mov_b32 m0, s38
    s_waitcnt vmcnt(32)
    buffer_load_dwordx4 v3, s[8:11], s37 offen offset:0 nt lds
    s_sub_i32 s7, s55, 4
    s_max_i32 s45, s45, s7
    v_mov_b32 v8, s45
    ds_write_b32 v7, v8
    s_memrealtime s[48:49]
    s_waitcnt vmcnt(32)
    buffer_load_dwordx4 v4, s[8:11], s37 offen offset:1024 nt lds
    s_add_u32 s7, s55, 1
    s_and_b32 s7, s7, 3
    s_lshl_b32 s7, s7, 2
    v_add_u32 v10, s7, v7
    s_waitcnt vmcnt(32)
    buffer_load_dwordx4 v5, s[8:11], s37 offen offset:2048 nt lds
    s_waitcnt vmcnt(32)
    buffer_load_dwordx4 v6, s[8:11], s37 offen offset:3072 nt lds
    s_add_u32 m0, s38, 4096
    s_add_u32 s37, s37, 4096
    s_waitcnt vmcnt(32)
    buffer_load_dwordx4 v3, s[8:11], s37 offen offset:0 nt lds
    s_waitcnt vmcnt(32)
    buffer_load_dwordx4 v4, s[8:11], s37 offen offset:1024 nt lds
    s_waitcnt vmcnt(32)
    buffer_load_dwordx4 v5, s[8:11], s37 offen offset:2048 nt lds
    ds_read_b32 v9, v10 offset:16
    s_waitcnt vmcnt(32)
    buffer_load_dwordx4 v6, s[8:11], s37 offen offset:3072 nt lds
L_next:
    s_add_u32 s37, s37, 4096
    s_add_u32 s55, s55, 1
    s_cmp_lg_u32 s55, 32
    s_cbranch_scc1 L_notv
    s_mov_b32 s8, s64
    s_mov_b32 s9, s65
    s_mov_b32 s37, s39
    v_lshlrev_b32 v3, 2, v1
    v_xor_b32 v3, v3, v2
    v_lshlrev_b32 v3, 4, v3
    v_lshl_add_u32 v3, v1, 8, v3
    v_mov_b32 v4, v3
    v_mov_b32 v5, v3
    v_mov_b32 v6, v3
L_notv:
    s_and_b32 s7, s55, 3
    s_cselect_b32 s7, 0, 8192
    s_add_u32 s56, s56, s7
    s_cmp_eq_u32 s56, 24576
    s_cselect_b32 s56, 0, s56
    s_cmp_lt_u32 s55, 64
    s_cbranch_scc1 L_loop
    s_load_dword s6, s[74:75], 0
    s_waitcnt vmcnt(32)
    s_max_i32 s45, s45, 60
    v_mov_b32 v8, s45
    ds_write_b32 v7, v8
    s_waitcnt vmcnt(24)
    s_max_i32 s45, s45, 61
    v_mov_b32 v8, s45
    ds_write_b32 v7, v8
    s_waitcnt vmcnt(16)
    s_max_i32 s45, s45, 62
    v_mov_b32 v8, s45
    ds_write_b32 v7, v8
    s_waitcnt vmcnt(8)
    s_max_i32 s45, s45, 63
    v_mov_b32 v8, s45
    ds_write_b32 v7, v8
    s_waitcnt vmcnt(0) lgkmcnt(0)
    s_max_i32 s45, s45, 64
    v_mov_b32 v8, s45
    ds_write_b32 v7, v8
    s_mov_b32 s28, s74
    s_mov_b32 s29, s75
    s_mov_b32 s30, 0x10000000
    s_mov_b32 s31, 0x20000
    s_mov_b32 s32, s70
    s_mov_b32 s33, s71
    s_mov_b32 s34, 0x10000
    s_mov_b32 s35, 0x20000
    s_mov_b32 s12, 0x70007
    s_movk_i32 s14, 138
    s_mov_b32 s15, 0xff760000
    s_waitcnt lgkmcnt(0)
    s_add_u32 s6, s6, 0x10001
    s_and_b32 s13, s6, s12
    s_branch L_T3
L_full:
    ds_read_b32 v9, v10 offset:16
    s_waitcnt lgkmcnt(0)
    v_readfirstlane_b32 s36, v9
    s_cmp_ge_u32 s36, s57
    s_cbranch_scc1 L_go
    s_waitcnt vmcnt(32)
    s_sub_u32 s7, s55, 4
    s_max_i32 s45, s45, s7
    v_mov_b32 v8, s45
    ds_write_b32 v7, v8
    ds_read_b32 v9, v10 offset:16
    s_waitcnt lgkmcnt(0)
    v_readfirstlane_b32 s36, v9
    s_cmp_ge_u32 s36, s57
    s_cbranch_scc1 L_go
    s_waitcnt vmcnt(24)
    s_sub_u32 s7, s55, 3
    s_max_i32 s45, s45, s7
    v_mov_b32 v8, s45
    ds_write_b32 v7, v8
    ds_read_b32 v9, v10 offset:16
    s_waitcnt lgkmcnt(0)
    v_readfirstlane_b32 s36, v9
    s_cmp_ge_u32 s36, s57
    s_cbranch_scc1 L_go
    s_waitcnt vmcnt(16)
    s_sub_u32 s7, s55, 2
    s_max_i32 s45, s45, s7
    v_mov_b32 v8, s45
    ds_write_b32 v7, v8
    ds_read_b32 v9, v10 offset:16
    s_waitcnt lgkmcnt(0)
    v_readfirstlane_b32 s36, v9
    s_cmp_ge_u32 s36, s57
    s_cbranch_scc1 L_go
    s_waitcnt vmcnt(8)
    s_sub_u32 s7, s55, 1
    s_max_i32 s45, s45, s7
    v_mov_b32 v8, s45
    ds_write_b32 v7, v8
    ds_read_b32 v9, v10 offset:16
    s_waitcnt lgkmcnt(0)
    v_readfirstlane_b32 s36, v9
    s_cmp_ge_u32 s36, s57
    s_cbranch_scc1 L_go
    s_waitcnt vmcnt(0)
    s_sub_u32 s7, s55, 0
    s_max_i32 s45, s45, s7
    v_mov_b32 v8, s45
    ds_write_b32 v7, v8
    s_mov_b32 s40, 0
Lw_1:
    ds_read_b32 v9, v10 offset:16
    s_add_u32 s40, s40, 1
    s_waitcnt lgkmcnt(0)
    v_readfirstlane_b32 s36, v9
    s_cmp_ge_u32 s36, s57
    s_cbranch_scc1 Lo_2
    s_sleep 1
    s_cmp_lt_u32 s40, 0x400000
    s_cbranch_scc1 Lw_1
Lo_2:
    s_branch L_go
L_notL:
    v_lshlrev_b32 v5, 4, v0
    v_and_b32 v14, 3, v0
    v_lshrrev_b32 v13, 2, v0
    s_waitcnt lgkmcnt(0)
    s_load_dword s6, s[74:75], 0
    s_cmp_ge_u32 s3, 4
    s_cbranch_scc1 L_A
    s_cmp_lg_u32 s3, 3
    s_cbranch_scc1 L_X
    s_setprio 3
    s_mov_b32 s16, s66
    s_mov_b32 s17, s67
    s_mov_b32 s18, 0x800000
    s_mov_b32 s19, 0x20000
    v_lshrrev_b32 v8, 3, v0
    v_and_b32 v9, 7, v0
    v_and_b32 v10, 2, v8
    v_xor_b32 v9, v9, v10
    v_lshlrev_b32 v9, 4, v9
    v_lshl_add_u32 v8, v8, 13, v9
    v_xor_b32 v9, 64, v8
    s_and_b32 s7, s4, 3
    s_lshl_b32 s37, s7, 21
    s_lshr_b32 s7, s4, 2
    s_lshl_b32 s7, s7, 7
    s_add_u32 s37, s37, s7
    s_mov_b32 s38, 0x18000
    s_mov_b32 s28, s74
    s_mov_b32 s29, s75
    s_mov_b32 s30, 0x10000000
    s_mov_b32 s31, 0x20000
    s_mov_b32 s32, s70
    s_mov_b32 s33, s71
    s_mov_b32 s34, 0x10000
    s_mov_b32 s35, 0x20000
    s_mov_b32 s12, 0x70007
    s_movk_i32 s14, 138
    s_mov_b32 s15, 0xff760000
    s_waitcnt lgkmcnt(0)
    s_add_u32 s6, s6, 0x10001
    s_and_b32 s13, s6, s12
    s_mov_b32 s40, 0
Lw_3:
    ds_read_b32 v3, v7 offset:44
    s_add_u32 s40, s40, 1
    s_waitcnt lgkmcnt(0)
    v_readfirstlane_b32 s7, v3
    s_cmp_ge_u32 s7, 1
    s_cbranch_scc1 Lo_4
    s_sleep 1
    s_cmp_lt_u32 s40, 0x400000
    s_cbranch_scc1 Lw_3
Lo_4:
L_Qloop:
    s_mov_b32 m0, s38
    s_waitcnt vmcnt(11)
    buffer_load_dwordx4 v8, s[16:19], s37 offen offset:0 lds
    s_add_u32 s37, s37, 0xfc00
    s_waitcnt vmcnt(11)
    buffer_load_dwordx4 v9, s[16:19], s37 offen offset:1024 lds
    s_add_u32 s37, s37, 0xfc00
    s_waitcnt vmcnt(11)
    buffer_load_dwordx4 v8, s[16:19], s37 offen offset:2048 lds
    s_add_u32 s37, s37, 0xfc00
    s_waitcnt vmcnt(11)
    buffer_load_dwordx4 v9, s[16:19], s37 offen offset:3072 lds
    s_add_u32 s37, s37, 0x10c00
    s_add_u32 s38, s38, 4096
    s_cmp_lt_u32 s38, 0x20000
    s_cbranch_scc1 L_Qloop
    s_waitcnt vmcnt(0)
    s_mov_b64 exec, 1
    v_mov_b32 v3, 1
    ds_add_u32 v7, v3 offset:36
    s_mov_b64 exec, -1
    s_mov_b32 s40, 0
Lw_5:
    ds_read_b32 v3, v7 offset:8
    s_add_u32 s40, s40, 1
    s_waitcnt lgkmcnt(0)
    v_readfirstlane_b32 s7, v3
    s_cmp_ge_u32 s7, 4
    s_cbranch_scc1 Lo_6
    s_sleep 1
    s_cmp_lt_u32 s40, 0x400000
    s_cbranch_scc1 Lw_5
Lo_6:
    v_and_b32 v6, 31, v0
    v_lshlrev_b32 v9, 3, v6
    v_add_u32 v9, 0x26000, v9
    ds_read_b64 v[16:17], v9
    ds_read_b64 v[18:19], v9 offset:256
    ds_read_b64 v[20:21], v9 offset:512
    ds_read_b64 v[22:23], v9 offset:768
    v_lshlrev_b32 v8, 4, v6
    s_lshl_b32 s37, s4, 9
    s_add_u32 s37, s37, 0x100000
    s_waitcnt lgkmcnt(0)
    v_max3_f32 v24, v16, v18, v20
    v_max_f32 v24, v24, v22
    v_sub_f32 v28, v16, v24
    v_sub_f32 v29, v18, v24
    v_sub_f32 v30, v20, v24
    v_sub_f32 v31, v22, v24
    v_exp_f32 v28, v28
    v_exp_f32 v29, v29
    v_exp_f32 v30, v30
    v_exp_f32 v31, v31
    v_mov_b32 v25, s6
    v_mul_f32 v26, v28, v17
    v_fmac_f32 v26, v29, v19
    v_fmac_f32 v26, v30, v21
    v_fmac_f32 v26, v31, v23
    v_mov_b32 v27, v25
    v_add_u32 v9, 0x26400, v8
    ds_write_b128 v9, v[28:31]
    s_mov_b32 exec_hi, 0
    buffer_store_dwordx4 v[24:27], v8, s[28:31], s37 offen sc1
    s_mov_b64 exec, -1
    s_waitcnt lgkmcnt(0)
    s_mov_b64 exec, 1
    v_mov_b32 v3, 1
    ds_add_u32 v7, v3 offset:32
    s_mov_b64 exec, -1
    s_getpc_b64 s[46:47]
L_pc2:
    s_add_u32 s46, s46, L_tailcode-L_pc2
    s_addc_u32 s47, s47, 0
    v_lshlrev_b32 v6, 7, v0
    v_min_u32 v6, L_end-L_tailcode, v6
    global_load_dword v41, v6, s[46:47]
    s_waitcnt vmcnt(0)
    s_mov_b32 s20, s68
    s_mov_b32 s21, s69
    s_mov_b32 s22, 0x800000
    s_mov_b32 s23, 0x20000
    v_lshlrev_b32 v8, 1, v1
    v_xor_b32 v8, v8, v2
    v_lshlrev_b32 v8, 4, v8
    v_lshl_add_u32 v8, v1, 11, v8
    v_xor_b32 v9, 0x80, v8
    s_lshr_b32 s37, s4, 3
    s_lshl_b32 s37, s37, 18
    s_and_b32 s7, s4, 7
    s_lshl_b32 s7, s7, 8
    s_add_u32 s37, s37, s7
    s_mov_b32 s38, 0x18000
    s_cmp_ge_u32 s45, 61
    s_cbranch_scc1 Lo_8
    s_mov_b32 s40, 0
Lw_7:
    ds_read_b32 v3, v7 offset:0
    s_add_u32 s40, s40, 1
    s_waitcnt lgkmcnt(0)
    v_readfirstlane_b32 s45, v3
    s_cmp_ge_u32 s45, 61
    s_cbranch_scc1 Lo_8
    s_sleep 1
    s_cmp_lt_u32 s40, 0x400000
    s_cbranch_scc1 Lw_7
Lo_8:
L_Wloop:
    s_mov_b32 m0, s38
    s_waitcnt vmcnt(17)
    buffer_load_dwordx4 v8, s[20:23], s37 offen offset:0 nt lds
    s_add_u32 s37, s37, 0x1c00
    s_waitcnt vmcnt(17)
    buffer_load_dwordx4 v9, s[20:23], s37 offen offset:1024 nt lds
    s_add_u32 s37, s37, 0x1c00
    s_waitcnt vmcnt(17)
    buffer_load_dwordx4 v8, s[20:23], s37 offen offset:2048 nt lds
    s_add_u32 s37, s37, 0x1c00
    s_waitcnt vmcnt(17)
    buffer_load_dwordx4 v9, s[20:23], s37 offen offset:3072 nt lds
    s_add_u32 s37, s37, 0x2c00
    s_add_u32 s38, s38, 4096
    s_cmp_lt_u32 s38, 0x20000
    s_cbranch_scc1 L_Wloop
    s_branch L_T3
L_X:
    s_setprio 2
    s_sub_u32 s44, s3, 1
    v_lshrrev_b32 v8, 5, v0
    v_and_b32 v9, 31, v0
    v_xor_b32 v9, v8, v9
    v_lshlrev_b32 v9, 4, v9
    v_lshl_add_u32 v8, v8, 11, v9
    s_and_b32 s7, s4, 3
    s_lshl_b32 s37, s7, 9
    s_lshl_b32 s7, s44, 15
    s_add_u32 s37, s37, s7
    s_lshl_b32 s38, s44, 13
    s_mov_b32 s24, s60
    s_mov_b32 s25, s61
    s_mov_b32 s26, 0x10000
    s_mov_b32 s27, 0x20000
    s_add_u32 m0, s38, 0x20000
    v_xor_b32 v9, 0x0, v8
    buffer_load_dwordx4 v9, s[24:27], s37 offen offset:0 lds
    s_add_u32 s37, s37, 3072
    v_xor_b32 v9, 0x20, v8
    buffer_load_dwordx4 v9, s[24:27], s37 offen offset:1024 lds
    s_add_u32 s37, s37, 3072
    v_xor_b32 v9, 0x40, v8
    buffer_load_dwordx4 v9, s[24:27], s37 offen offset:2048 lds
    s_add_u32 s37, s37, 3072
    v_xor_b32 v9, 0x60, v8
    buffer_load_dwordx4 v9, s[24:27], s37 offen offset:3072 lds
    s_add_u32 s37, s37, 7168
    s_add_u32 m0, s38, 0x21000
    v_xor_b32 v9, 0x80, v8
    buffer_load_dwordx4 v9, s[24:27], s37 offen offset:0 lds
    s_add_u32 s37, s37, 3072
    v_xor_b32 v9, 0xa0, v8
    buffer_load_dwordx4 v9, s[24:27], s37 offen offset:1024 lds
    s_add_u32 s37, s37, 3072
    v_xor_b32 v9, 0xc0, v8
    buffer_load_dwordx4 v9, s[24:27], s37 offen offset:2048 lds
    s_add_u32 s37, s37, 3072
    v_xor_b32 v9, 0xe0, v8
    buffer_load_dwordx4 v9, s[24:27], s37 offen offset:3072 lds
    s_mov_b32 s28, s74
    s_mov_b32 s29, s75
    s_mov_b32 s30, 0x10000000
    s_mov_b32 s31, 0x20000
    s_mov_b32 s32, s70
    s_mov_b32 s33, s71
    s_mov_b32 s34, 0x10000
    s_mov_b32 s35, 0x20000
    s_mov_b32 s12, 0x70007
    s_movk_i32 s14, 138
    s_mov_b32 s15, 0xff760000
    s_waitcnt lgkmcnt(0)
    s_add_u32 s6, s6, 0x10001
    s_and_b32 s13, s6, s12
    v_lshrrev_b32 v9, 2, v2
    v_lshl_add_u32 v9, v1, 3, v9
    v_lshlrev_b32 v8, 7, v9
    v_lshl_add_u32 v8, v14, 3, v8
    v_bfe_u32 v9, v0, 3, 2
    v_lshl_add_u32 v8, v9, 5, v8
    s_lshl_b32 s7, s44, 6
    s_add_u32 s7, s7, 0x18000
    v_xor_b32 v8, s7, v8
    v_xor_b32 v4, 32, v8
    v_xor_b32 v9, v1, v2
    v_lshlrev_b32 v9, 4, v9
    v_lshl_add_u32 v9, v2, 9, v9
    v_add_u32 v9, 0x20000, v9
    v_xor_b32 v10, 64, v9
    v_xor_b32 v11, 0x80, v9
    v_xor_b32 v12, 0xc0, v9
    v_lshrrev_b32 v6, 2, v2
    v_lshlrev_b32 v6, 9, v6
    v_lshl_add_u32 v6, v1, 6, v6
    v_lshl_add_u32 v6, v14, 4, v6
    s_lshl_b32 s37, s4, 12
    s_lshl_b32 s7, s44, 8
    s_add_u32 s37, s37, s7
    s_add_u32 s37, s37, 0x600000
    v_mov_b32 v160, s13
    v_mov_b32 v161, 0x40020
    s_waitcnt vmcnt(0)
    s_mov_b64 exec, 1
    v_mov_b32 v3, 1
    ds_add_u32 v7, v3 offset:36
    s_mov_b64 exec, -1
    s_mov_b32 s40, 0
Lw_9:
    ds_read_b32 v3, v7 offset:36
    s_add_u32 s40, s40, 1
    s_waitcnt lgkmcnt(0)
    v_readfirstlane_b32 s7, v3
    s_cmp_ge_u32 s7, 3
    s_cbranch_scc1 Lo_10
    s_sleep 1
    s_cmp_lt_u32 s40, 0x400000
    s_cbranch_scc1 Lw_9
Lo_10:
    ds_read_b64_tr_b16 v[32:33], v8 offset:0
    ds_read_b64_tr_b16 v[34:35], v8 offset:512
    ds_read_b64_tr_b16 v[36:37], v4 offset:0
    ds_read_b64_tr_b16 v[38:39], v4 offset:512
    ds_read_b128 v[96:99], v9 offset:0
    ds_read_b128 v[100:103], v9 offset:8192
    ds_read_b64_tr_b16 v[40:41], v8 offset:4096
    ds_read_b64_tr_b16 v[42:43], v8 offset:4608
    ds_read_b64_tr_b16 v[44:45], v4 offset:4096
    ds_read_b64_tr_b16 v[46:47], v4 offset:4608
    ds_read_b128 v[104:107], v10 offset:0
    ds_read_b128 v[108:111], v10 offset:8192
    s_waitcnt lgkmcnt(6)
    v_mfma_f32_16x16x32_bf16 v[16:19], v[32:35], v[96:99], 0
    v_mfma_f32_16x16x32_bf16 v[20:23], v[32:35], v[100:103], 0
    v_mfma_f32_16x16x32_bf16 v[24:27], v[36:39], v[96:99], 0
    v_mfma_f32_16x16x32_bf16 v[28:31], v[36:39], v[100:103], 0
    ds_read_b64_tr_b16 v[48:49], v8 offset:8192
    ds_read_b64_tr_b16 v[50:51], v8 offset:8704
    ds_read_b64_tr_b16 v[52:53], v4 offset:8192
    ds_read_b64_tr_b16 v[54:55], v4 offset:8704
    ds_read_b128 v[112:115], v11 offset:0
    ds_read_b128 v[116:119], v11 offset:8192
    s_waitcnt lgkmcnt(6)
    v_mfma_f32_16x16x32_bf16 v[16:19], v[40:43], v[104:107], v[16:19]
    v_mfma_f32_16x16x32_bf16 v[20:23], v[40:43], v[108:111], v[20:23]
    v_mfma_f32_16x16x32_bf16 v[24:27], v[44:47], v[104:107], v[24:27]
    v_mfma_f32_16x16x32_bf16 v[28:31], v[44:47], v[108:111], v[28:31]
    ds_read_b64_tr_b16 v[56:57], v8 offset:12288
    ds_read_b64_tr_b16 v[58:59], v8 offset:12800
    ds_read_b64_tr_b16 v[60:61], v4 offset:12288
    ds_read_b64_tr_b16 v[62:63], v4 offset:12800
    ds_read_b128 v[120:123], v12 offset:0
    ds_read_b128 v[124:127], v12 offset:8192
    s_waitcnt lgkmcnt(6)
    v_mfma_f32_16x16x32_bf16 v[16:19], v[48:51], v[112:115], v[16:19]
    v_mfma_f32_16x16x32_bf16 v[20:23], v[48:51], v[116:119], v[20:23]
    v_mfma_f32_16x16x32_bf16 v[24:27], v[52:55], v[112:115], v[24:27]
    v_mfma_f32_16x16x32_bf16 v[28:31], v[52:55], v[116:119], v[28:31]
    ds_read_b64_tr_b16 v[64:65], v8 offset:16384
    ds_read_b64_tr_b16 v[66:67], v8 offset:16896
    ds_read_b64_tr_b16 v[68:69], v4 offset:16384
    ds_read_b64_tr_b16 v[70:71], v4 offset:16896
    ds_read_b128 v[128:131], v9 offset:256
    ds_read_b128 v[132:135], v9 offset:8448
    s_waitcnt lgkmcnt(6)
    v_mfma_f32_16x16x32_bf16 v[16:19], v[56:59], v[120:123], v[16:19]
    v_mfma_f32_16x16x32_bf16 v[20:23], v[56:59], v[124:127], v[20:23]
    v_mfma_f32_16x16x32_bf16 v[24:27], v[60:63], v[120:123], v[24:27]
    v_mfma_f32_16x16x32_bf16 v[28:31], v[60:63], v[124:127], v[28:31]
    ds_read_b64_tr_b16 v[72:73], v8 offset:20480
    ds_read_b64_tr_b16 v[74:75], v8 offset:20992
    ds_read_b64_tr_b16 v[76:77], v4 offset:20480
    ds_read_b64_tr_b16 v[78:79], v4 offset:20992
    ds_read_b128 v[136:139], v10 offset:256
    ds_read_b128 v[140:143], v10 offset:8448
    s_waitcnt lgkmcnt(6)
    v_mfma_f32_16x16x32_bf16 v[16:19], v[64:67], v[128:131], v[16:19]
    v_mfma_f32_16x16x32_bf16 v[20:23], v[64:67], v[132:135], v[20:23]
    v_mfma_f32_16x16x32_bf16 v[24:27], v[68:71], v[128:131], v[24:27]
    v_mfma_f32_16x16x32_bf16 v[28:31], v[68:71], v[132:135], v[28:31]
    ds_read_b64_tr_b16 v[80:81], v8 offset:24576
    ds_read_b64_tr_b16 v[82:83], v8 offset:25088
    ds_read_b64_tr_b16 v[84:85], v4 offset:24576
    ds_read_b64_tr_b16 v[86:87], v4 offset:25088
    ds_read_b128 v[144:147], v11 offset:256
    ds_read_b128 v[148:151], v11 offset:8448
    s_waitcnt lgkmcnt(6)
    v_mfma_f32_16x16x32_bf16 v[16:19], v[72:75], v[136:139], v[16:19]
    v_mfma_f32_16x16x32_bf16 v[20:23], v[72:75], v[140:143], v[20:23]
    v_mfma_f32_16x16x32_bf16 v[24:27], v[76:79], v[136:139], v[24:27]
    v_mfma_f32_16x16x32_bf16 v[28:31], v[76:79], v[140:143], v[28:31]
    ds_read_b64_tr_b16 v[88:89], v8 offset:28672
    ds_read_b64_tr_b16 v[90:91], v8 offset:29184
    ds_read_b64_tr_b16 v[92:93], v4 offset:28672
    ds_read_b64_tr_b16 v[94:95], v4 offset:29184
    ds_read_b128 v[152:155], v12 offset:256
    ds_read_b128 v[156:159], v12 offset:8448
    s_waitcnt lgkmcnt(6)
    v_mfma_f32_16x16x32_bf16 v[16:19], v[80:83], v[144:147], v[16:19]
    v_mfma_f32_16x16x32_bf16 v[20:23], v[80:83], v[148:151], v[20:23]
    v_mfma_f32_16x16x32_bf16 v[24:27], v[84:87], v[144:147], v[24:27]
    v_mfma_f32_16x16x32_bf16 v[28:31], v[84:87], v[148:151], v[28:31]
    s_waitcnt lgkmcnt(0)
    v_mfma_f32_16x16x32_bf16 v[16:19], v[88:91], v[152:155], v[16:19]
    v_mfma_f32_16x16x32_bf16 v[20:23], v[88:91], v[156:159], v[20:23]
    v_mfma_f32_16x16x32_bf16 v[24:27], v[92:95], v[152:155], v[24:27]
    v_mfma_f32_16x16x32_bf16 v[28:31], v[92:95], v[156:159], v[28:31]
    s_nop 7
    v_max3_f32 v8, |v16|, |v17|, |v18|
    v_max3_f32 v8, v8, |v19|, |v24|
    v_max3_f32 v8, v8, |v25|, |v26|
    v_max_f32_e64 v8, v8, |v27|
    v_lshrrev_b32 v8, 25, v8
    v_mad_i32_i24 v9, v8, -4, s14
    v_mul_u32_u24 v8, 0x2001, v8
    v_ldexp_f32 v16, v16, v9
    v_ldexp_f32 v17, v17, v9
    v_ldexp_f32 v18, v18, v9
    v_ldexp_f32 v19, v19, v9
    v_ldexp_f32 v24, v24, v9
    v_ldexp_f32 v25, v25, v9
    v_ldexp_f32 v26, v26, v9
    v_ldexp_f32 v27, v27, v9
    v_cvt_pkrtz_f16_f32 v32, v16, v17
    v_cvt_pkrtz_f16_f32 v33, v18, v19
    v_cvt_pkrtz_f16_f32 v34, v24, v25
    v_cvt_pkrtz_f16_f32 v35, v26, v27
    v_pk_add_u16 v32, v32, 4 op_sel_hi:[1,0]
    v_pk_add_u16 v33, v33, 4 op_sel_hi:[1,0]
    v_pk_add_u16 v34, v34, 4 op_sel_hi:[1,0]
    v_pk_add_u16 v35, v35, 4 op_sel_hi:[1,0]
    v_bfi_b32 v32, s12, v8, v32
    v_bfi_b32 v33, s12, v160, v33
    v_bfi_b32 v34, s12, v160, v34
    v_bfi_b32 v35, s12, v160, v35
    buffer_store_dwordx4 v[32:35], v6, s[28:31], s37 offen offset:0 sc1
    v_max3_f32 v8, |v20|, |v21|, |v22|
    v_max3_f32 v8, v8, |v23|, |v28|
    v_max3_f32 v8, v8, |v29|, |v30|
    v_max_f32_e64 v8, v8, |v31|
    v_lshrrev_b32 v8, 25, v8
    v_mad_i32_i24 v9, v8, -4, s14
    v_mul_u32_u24 v8, 0x2001, v8
    v_ldexp_f32 v20, v20, v9
    v_ldexp_f32 v21, v21, v9
    v_ldexp_f32 v22, v22, v9
    v_ldexp_f32 v23, v23, v9
    v_ldexp_f32 v28, v28, v9
    v_ldexp_f32 v29, v29, v9
    v_ldexp_f32 v30, v30, v9
    v_ldexp_f32 v31, v31, v9
    v_cvt_pkrtz_f16_f32 v36, v20, v21
    v_cvt_pkrtz_f16_f32 v37, v22, v23
    v_cvt_pkrtz_f16_f32 v38, v28, v29
    v_cvt_pkrtz_f16_f32 v39, v30, v31
    v_pk_add_u16 v36, v36, 4 op_sel_hi:[1,0]
    v_pk_add_u16 v37, v37, 4 op_sel_hi:[1,0]
    v_pk_add_u16 v38, v38, 4 op_sel_hi:[1,0]
    v_pk_add_u16 v39, v39, 4 op_sel_hi:[1,0]
    v_bfi_b32 v36, s12, v8, v36
    v_bfi_b32 v37, s12, v160, v37
    v_bfi_b32 v38, s12, v160, v38
    v_bfi_b32 v39, s12, v160, v39
    buffer_store_dwordx4 v[36:39], v6, s[28:31], s37 offen offset:2048 sc1
    v_lshlrev_b32 v6, 11, v1
    v_and_b32 v8, 8, v0
    v_lshl_add_u32 v6, v8, 6, v6
    v_lshl_add_u32 v6, v14, 4, v6
    v_and_b32 v8, 4, v0
    v_lshl_add_u32 v6, v8, 1, v6
    s_lshl_b32 s7, s44, 8
    s_add_u32 s7, s7, 0x24000
    v_add_u32 v6, s7, v6
    s_lshr_b32 s39, s4, 3
    s_and_b32 s39, s39, 3
    s_lshl_b32 s39, s39, 1
    s_add_u32 s39, s39, s44
    s_lshl_b32 s39, s39, 17
    s_lshr_b32 s7, s4, 5
    s_lshl_b32 s7, s7, 9
    s_add_u32 s39, s39, s7
    s_add_u32 s39, s39, 0x600000
    v_lshrrev_b32 v10, 5, v0
    v_lshlrev_b32 v10, 14, v10
    v_and_b32 v11, 31, v0
    v_lshl_add_u32 v10, v11, 4, v10
    s_cmp_ge_u32 s45, 15
    s_cbranch_scc1 Lo_12
    s_mov_b32 s40, 0
Lw_11:
    ds_read_b32 v3, v7 offset:0
    s_add_u32 s40, s40, 1
    s_waitcnt lgkmcnt(0)
    v_readfirstlane_b32 s45, v3
    s_cmp_ge_u32 s45, 15
    s_cbranch_scc1 Lo_12
    s_sleep 1
    s_cmp_lt_u32 s40, 0x400000
    s_cbranch_scc1 Lw_11
Lo_12:
    s_mov_b32 s40, 0
    s_branch Lp_13
Lr_14:
    s_add_u32 s40, s40, 1
    s_cmp_ge_u32 s40, 40000
    s_cbranch_scc1 Lk_15
    s_sleep 4
Lp_13:
    s_add_u32 s37, s39, 0
    buffer_load_dwordx4 v[48:51], v10, s[28:31], s37 offen sc1
    s_add_u32 s37, s39, 4096
    buffer_load_dwordx4 v[52:55], v10, s[28:31], s37 offen sc1
    s_add_u32 s37, s39, 8192
    buffer_load_dwordx4 v[56:59], v10, s[28:31], s37 offen sc1
    s_add_u32 s37, s39, 12288
    buffer_load_dwordx4 v[60:63], v10, s[28:31], s37 offen sc1
    s_add_u32 s37, s39, 32768
    buffer_load_dwordx4 v[64:67], v10, s[28:31], s37 offen sc1
    s_add_u32 s37, s39, 36864
    buffer_load_dwordx4 v[68:71], v10, s[28:31], s37 offen sc1
    s_add_u32 s37, s39, 40960
    buffer_load_dwordx4 v[72:75], v10, s[28:31], s37 offen sc1
    s_add_u32 s37, s39, 45056
    buffer_load_dwordx4 v[76:79], v10, s[28:31], s37 offen sc1
    s_add_u32 s37, s39, 65536
    buffer_load_dwordx4 v[80:83], v10, s[28:31], s37 offen sc1
    s_add_u32 s37, s39, 69632
    buffer_load_dwordx4 v[84:87], v10, s[28:31], s37 offen sc1
    s_add_u32 s37, s39, 73728
    buffer_load_dwordx4 v[88:91], v10, s[28:31], s37 offen sc1
    s_add_u32 s37, s39, 77824
    buffer_load_dwordx4 v[92:95], v10, s[28:31], s37 offen sc1
    s_add_u32 s37, s39, 98304
    buffer_load_dwordx4 v[96:99], v10, s[28:31], s37 offen sc1
    s_add_u32 s37, s39, 102400
    buffer_load_dwordx4 v[100:103], v10, s[28:31], s37 offen sc1
    s_add_u32 s37, s39, 106496
    buffer_load_dwordx4 v[104:107], v10, s[28:31], s37 offen sc1
    s_add_u32 s37, s39, 110592
    buffer_load_dwordx4 v[108:111], v10, s[28:31], s37 offen sc1
    s_waitcnt vmcnt(0)
    v_xor_b32 v49, s13, v49
    v_xor_b32 v50, s13, v50
    v_xor_b32 v51, s13, v51
    v_or3_b32 v8, v49, v50, v51
    v_xor_b32 v53, s13, v53
    v_xor_b32 v54, s13, v54
    v_xor_b32 v55, s13, v55
    v_or3_b32 v8, v8, v53, v54
    v_xor_b32 v57, s13, v57
    v_xor_b32 v58, s13, v58
    v_xor_b32 v59, s13, v59
    v_or3_b32 v8, v8, v55, v57
    v_or3_b32 v8, v8, v58, v59
    v_xor_b32 v61, s13, v61
    v_xor_b32 v62, s13, v62
    v_xor_b32 v63, s13, v63
    v_or3_b32 v8, v8, v61, v62
    v_xor_b32 v65, s13, v65
    v_xor_b32 v66, s13, v66
    v_xor_b32 v67, s13, v67
    v_or3_b32 v8, v8, v63, v65
    v_or3_b32 v8, v8, v66, v67
    v_xor_b32 v69, s13, v69
    v_xor_b32 v70, s13, v70
    v_xor_b32 v71, s13, v71
    v_or3_b32 v8, v8, v69, v70
    v_xor_b32 v73, s13, v73
    v_xor_b32 v74, s13, v74
    v_xor_b32 v75, s13, v75
    v_or3_b32 v8, v8, v71, v73
    v_or3_b32 v8, v8, v74, v75
    v_xor_b32 v77, s13, v77
    v_xor_b32 v78, s13, v78
    v_xor_b32 v79, s13, v79
    v_or3_b32 v8, v8, v77, v78
    v_xor_b32 v81, s13, v81
    v_xor_b32 v82, s13, v82
    v_xor_b32 v83, s13, v83
    v_or3_b32 v8, v8, v79, v81
    v_or3_b32 v8, v8, v82, v83
    v_xor_b32 v85, s13, v85
    v_xor_b32 v86, s13, v86
    v_xor_b32 v87, s13, v87
    v_or3_b32 v8, v8, v85, v86
    v_xor_b32 v89, s13, v89
    v_xor_b32 v90, s13, v90
    v_xor_b32 v91, s13, v91
    v_or3_b32 v8, v8, v87, v89
    v_or3_b32 v8, v8, v90, v91
    v_xor_b32 v93, s13, v93
    v_xor_b32 v94, s13, v94
    v_xor_b32 v95, s13, v95
    v_or3_b32 v8, v8, v93, v94
    v_xor_b32 v97, s13, v97
    v_xor_b32 v98, s13, v98
    v_xor_b32 v99, s13, v99
    v_or3_b32 v8, v8, v95, v97
    v_or3_b32 v8, v8, v98, v99
    v_xor_b32 v101, s13, v101
    v_xor_b32 v102, s13, v102
    v_xor_b32 v103, s13, v103
    v_or3_b32 v8, v8, v101, v102
    v_xor_b32 v105, s13, v105
    v_xor_b32 v106, s13, v106
    v_xor_b32 v107, s13, v107
    v_or3_b32 v8, v8, v103, v105
    v_or3_b32 v8, v8, v106, v107
    v_xor_b32 v109, s13, v109
    v_xor_b32 v110, s13, v110
    v_xor_b32 v111, s13, v111
    v_or3_b32 v8, v8, v109, v110
    v_or_b32 v8, v8, v111
    v_and_b32 v8, s12, v8
    v_cmp_ne_u32 vcc, 0, v8
    s_cbranch_vccnz Lr_14
Lk_15:
    v_and_b32 v8, s12, v48
    v_xor_b32 v48, v48, v8
    v_mad_u32_u24 v8, v8, v161, s15
    v_ashrrev_i32 v8, 16, v8
    v_ldexp_f32 v8, 1.0, v8
    v_fma_mix_f32 v16, v48, v8, 0 op_sel_hi:[1,0,0]
    v_fma_mix_f32 v17, v48, v8, 0 op_sel:[1,0,0] op_sel_hi:[1,0,0]
    v_fma_mix_f32 v18, v49, v8, 0 op_sel_hi:[1,0,0]
    v_fma_mix_f32 v19, v49, v8, 0 op_sel:[1,0,0] op_sel_hi:[1,0,0]
    v_fma_mix_f32 v20, v50, v8, 0 op_sel_hi:[1,0,0]
    v_fma_mix_f32 v21, v50, v8, 0 op_sel:[1,0,0] op_sel_hi:[1,0,0]
    v_fma_mix_f32 v22, v51, v8, 0 op_sel_hi:[1,0,0]
    v_fma_mix_f32 v23, v51, v8, 0 op_sel:[1,0,0] op_sel_hi:[1,0,0]
    v_and_b32 v8, s12, v52
    v_xor_b32 v52, v52, v8
    v_mad_u32_u24 v8, v8, v161, s15
    v_ashrrev_i32 v8, 16, v8
    v_ldexp_f32 v8, 1.0, v8
    v_fma_mix_f32 v16, v52, v8, v16 op_sel_hi:[1,0,0]
    v_fma_mix_f32 v17, v52, v8, v17 op_sel:[1,0,0] op_sel_hi:[1,0,0]
    v_fma_mix_f32 v18, v53, v8, v18 op_sel_hi:[1,0,0]
    v_fma_mix_f32 v19, v53, v8, v19 op_sel:[1,0,0] op_sel_hi:[1,0,0]
    v_fma_mix_f32 v20, v54, v8, v20 op_sel_hi:[1,0,0]
    v_fma_mix_f32 v21, v54, v8, v21 op_sel:[1,0,0] op_sel_hi:[1,0,0]
    v_fma_mix_f32 v22, v55, v8, v22 op_sel_hi:[1,0,0]
    v_fma_mix_f32 v23, v55, v8, v23 op_sel:[1,0,0] op_sel_hi:[1,0,0]
    v_and_b32 v8, s12, v56
    v_xor_b32 v56, v56, v8
    v_mad_u32_u24 v8, v8, v161, s15
    v_ashrrev_i32 v8, 16, v8
    v_ldexp_f32 v8, 1.0, v8
    v_fma_mix_f32 v16, v56, v8, v16 op_sel_hi:[1,0,0]
    v_fma_mix_f32 v17, v56, v8, v17 op_sel:[1,0,0] op_sel_hi:[1,0,0]
    v_fma_mix_f32 v18, v57, v8, v18 op_sel_hi:[1,0,0]
    v_fma_mix_f32 v19, v57, v8, v19 op_sel:[1,0,0] op_sel_hi:[1,0,0]
    v_fma_mix_f32 v20, v58, v8, v20 op_sel_hi:[1,0,0]
    v_fma_mix_f32 v21, v58, v8, v21 op_sel:[1,0,0] op_sel_hi:[1,0,0]
    v_fma_mix_f32 v22, v59, v8, v22 op_sel_hi:[1,0,0]
    v_fma_mix_f32 v23, v59, v8, v23 op_sel:[1,0,0] op_sel_hi:[1,0,0]
    v_and_b32 v8, s12, v60
    v_xor_b32 v60, v60, v8
    v_mad_u32_u24 v8, v8, v161, s15
    v_ashrrev_i32 v8, 16, v8
    v_ldexp_f32 v8, 1.0, v8
    v_fma_mix_f32 v16, v60, v8, v16 op_sel_hi:[1,0,0]
    v_fma_mix_f32 v17, v60, v8, v17 op_sel:[1,0,0] op_sel_hi:[1,0,0]
    v_fma_mix_f32 v18, v61, v8, v18 op_sel_hi:[1,0,0]
    v_fma_mix_f32 v19, v61, v8, v19 op_sel:[1,0,0] op_sel_hi:[1,0,0]
    v_fma_mix_f32 v20, v62, v8, v20 op_sel_hi:[1,0,0]
    v_fma_mix_f32 v21, v62, v8, v21 op_sel:[1,0,0] op_sel_hi:[1,0,0]
    v_fma_mix_f32 v22, v63, v8, v22 op_sel_hi:[1,0,0]
    v_fma_mix_f32 v23, v63, v8, v23 op_sel:[1,0,0] op_sel_hi:[1,0,0]
    v_cvt_pk_bf16_f32 v24, v16, v17
    v_cvt_pk_bf16_f32 v25, v18, v19
    v_cvt_pk_bf16_f32 v26, v20, v21
    v_cvt_pk_bf16_f32 v27, v22, v23
    ds_write_b64 v6, v[24:25] offset:0
    ds_write_b64 v6, v[26:27] offset:1024
    v_and_b32 v8, s12, v64
    v_xor_b32 v64, v64, v8
    v_mad_u32_u24 v8, v8, v161, s15
    v_ashrrev_i32 v8, 16, v8
    v_ldexp_f32 v8, 1.0, v8
    v_fma_mix_f32 v16, v64, v8, 0 op_sel_hi:[1,0,0]
    v_fma_mix_f32 v17, v64, v8, 0 op_sel:[1,0,0] op_sel_hi:[1,0,0]
    v_fma_mix_f32 v18, v65, v8, 0 op_sel_hi:[1,0,0]
    v_fma_mix_f32 v19, v65, v8, 0 op_sel:[1,0,0] op_sel_hi:[1,0,0]
    v_fma_mix_f32 v20, v66, v8, 0 op_sel_hi:[1,0,0]
    v_fma_mix_f32 v21, v66, v8, 0 op_sel:[1,0,0] op_sel_hi:[1,0,0]
    v_fma_mix_f32 v22, v67, v8, 0 op_sel_hi:[1,0,0]
    v_fma_mix_f32 v23, v67, v8, 0 op_sel:[1,0,0] op_sel_hi:[1,0,0]
    v_and_b32 v8, s12, v68
    v_xor_b32 v68, v68, v8
    v_mad_u32_u24 v8, v8, v161, s15
    v_ashrrev_i32 v8, 16, v8
    v_ldexp_f32 v8, 1.0, v8
    v_fma_mix_f32 v16, v68, v8, v16 op_sel_hi:[1,0,0]
    v_fma_mix_f32 v17, v68, v8, v17 op_sel:[1,0,0] op_sel_hi:[1,0,0]
    v_fma_mix_f32 v18, v69, v8, v18 op_sel_hi:[1,0,0]
    v_fma_mix_f32 v19, v69, v8, v19 op_sel:[1,0,0] op_sel_hi:[1,0,0]
    v_fma_mix_f32 v20, v70, v8, v20 op_sel_hi:[1,0,0]
    v_fma_mix_f32 v21, v70, v8, v21 op_sel:[1,0,0] op_sel_hi:[1,0,0]
    v_fma_mix_f32 v22, v71, v8, v22 op_sel_hi:[1,0,0]
    v_fma_mix_f32 v23, v71, v8, v23 op_sel:[1,0,0] op_sel_hi:[1,0,0]
    v_and_b32 v8, s12, v72
    v_xor_b32 v72, v72, v8
    v_mad_u32_u24 v8, v8, v161, s15
    v_ashrrev_i32 v8, 16, v8
    v_ldexp_f32 v8, 1.0, v8
    v_fma_mix_f32 v16, v72, v8, v16 op_sel_hi:[1,0,0]
    v_fma_mix_f32 v17, v72, v8, v17 op_sel:[1,0,0] op_sel_hi:[1,0,0]
    v_fma_mix_f32 v18, v73, v8, v18 op_sel_hi:[1,0,0]
    v_fma_mix_f32 v19, v73, v8, v19 op_sel:[1,0,0] op_sel_hi:[1,0,0]
    v_fma_mix_f32 v20, v74, v8, v20 op_sel_hi:[1,0,0]
    v_fma_mix_f32 v21, v74, v8, v21 op_sel:[1,0,0] op_sel_hi:[1,0,0]
    v_fma_mix_f32 v22, v75, v8, v22 op_sel_hi:[1,0,0]
    v_fma_mix_f32 v23, v75, v8, v23 op_sel:[1,0,0] op_sel_hi:[1,0,0]
    v_and_b32 v8, s12, v76
    v_xor_b32 v76, v76, v8
    v_mad_u32_u24 v8, v8, v161, s15
    v_ashrrev_i32 v8, 16, v8
    v_ldexp_f32 v8, 1.0, v8
    v_fma_mix_f32 v16, v76, v8, v16 op_sel_hi:[1,0,0]
    v_fma_mix_f32 v17, v76, v8, v17 op_sel:[1,0,0] op_sel_hi:[1,0,0]
    v_fma_mix_f32 v18, v77, v8, v18 op_sel_hi:[1,0,0]
    v_fma_mix_f32 v19, v77, v8, v19 op_sel:[1,0,0] op_sel_hi:[1,0,0]
    v_fma_mix_f32 v20, v78, v8, v20 op_sel_hi:[1,0,0]
    v_fma_mix_f32 v21, v78, v8, v21 op_sel:[1,0,0] op_sel_hi:[1,0,0]
    v_fma_mix_f32 v22, v79, v8, v22 op_sel_hi:[1,0,0]
    v_fma_mix_f32 v23, v79, v8, v23 op_sel:[1,0,0] op_sel_hi:[1,0,0]
    v_cvt_pk_bf16_f32 v28, v16, v17
    v_cvt_pk_bf16_f32 v29, v18, v19
    v_cvt_pk_bf16_f32 v30, v20, v21
    v_cvt_pk_bf16_f32 v31, v22, v23
    ds_write_b64 v6, v[28:29] offset:64
    ds_write_b64 v6, v[30:31] offset:1088
    v_and_b32 v8, s12, v80
    v_xor_b32 v80, v80, v8
    v_mad_u32_u24 v8, v8, v161, s15
    v_ashrrev_i32 v8, 16, v8
    v_ldexp_f32 v8, 1.0, v8
    v_fma_mix_f32 v16, v80, v8, 0 op_sel_hi:[1,0,0]
    v_fma_mix_f32 v17, v80, v8, 0 op_sel:[1,0,0] op_sel_hi:[1,0,0]
    v_fma_mix_f32 v18, v81, v8, 0 op_sel_hi:[1,0,0]
    v_fma_mix_f32 v19, v81, v8, 0 op_sel:[1,0,0] op_sel_hi:[1,0,0]
    v_fma_mix_f32 v20, v82, v8, 0 op_sel_hi:[1,0,0]
    v_fma_mix_f32 v21, v82, v8, 0 op_sel:[1,0,0] op_sel_hi:[1,0,0]
    v_fma_mix_f32 v22, v83, v8, 0 op_sel_hi:[1,0,0]
    v_fma_mix_f32 v23, v83, v8, 0 op_sel:[1,0,0] op_sel_hi:[1,0,0]
    v_and_b32 v8, s12, v84
    v_xor_b32 v84, v84, v8
    v_mad_u32_u24 v8, v8, v161, s15
    v_ashrrev_i32 v8, 16, v8
    v_ldexp_f32 v8, 1.0, v8
    v_fma_mix_f32 v16, v84, v8, v16 op_sel_hi:[1,0,0]
    v_fma_mix_f32 v17, v84, v8, v17 op_sel:[1,0,0] op_sel_hi:[1,0,0]
    v_fma_mix_f32 v18, v85, v8, v18 op_sel_hi:[1,0,0]
    v_fma_mix_f32 v19, v85, v8, v19 op_sel:[1,0,0] op_sel_hi:[1,0,0]
    v_fma_mix_f32 v20, v86, v8, v20 op_sel_hi:[1,0,0]
    v_fma_mix_f32 v21, v86, v8, v21 op_sel:[1,0,0] op_sel_hi:[1,0,0]
    v_fma_mix_f32 v22, v87, v8, v22 op_sel_hi:[1,0,0]
    v_fma_mix_f32 v23, v87, v8, v23 op_sel:[1,0,0] op_sel_hi:[1,0,0]
    v_and_b32 v8, s12, v88
    v_xor_b32 v88, v88, v8
    v_mad_u32_u24 v8, v8, v161, s15
    v_ashrrev_i32 v8, 16, v8
    v_ldexp_f32 v8, 1.0, v8
    v_fma_mix_f32 v16, v88, v8, v16 op_sel_hi:[1,0,0]
    v_fma_mix_f32 v17, v88, v8, v17 op_sel:[1,0,0] op_sel_hi:[1,0,0]
    v_fma_mix_f32 v18, v89, v8, v18 op_sel_hi:[1,0,0]
    v_fma_mix_f32 v19, v89, v8, v19 op_sel:[1,0,0] op_sel_hi:[1,0,0]
    v_fma_mix_f32 v20, v90, v8, v20 op_sel_hi:[1,0,0]
    v_fma_mix_f32 v21, v90, v8, v21 op_sel:[1,0,0] op_sel_hi:[1,0,0]
    v_fma_mix_f32 v22, v91, v8, v22 op_sel_hi:[1,0,0]
    v_fma_mix_f32 v23, v91, v8, v23 op_sel:[1,0,0] op_sel_hi:[1,0,0]
    v_and_b32 v8, s12, v92
    v_xor_b32 v92, v92, v8
    v_mad_u32_u24 v8, v8, v161, s15
    v_ashrrev_i32 v8, 16, v8
    v_ldexp_f32 v8, 1.0, v8
    v_fma_mix_f32 v16, v92, v8, v16 op_sel_hi:[1,0,0]
    v_fma_mix_f32 v17, v92, v8, v17 op_sel:[1,0,0] op_sel_hi:[1,0,0]
    v_fma_mix_f32 v18, v93, v8, v18 op_sel_hi:[1,0,0]
    v_fma_mix_f32 v19, v93, v8, v19 op_sel:[1,0,0] op_sel_hi:[1,0,0]
    v_fma_mix_f32 v20, v94, v8, v20 op_sel_hi:[1,0,0]
    v_fma_mix_f32 v21, v94, v8, v21 op_sel:[1,0,0] op_sel_hi:[1,0,0]
    v_fma_mix_f32 v22, v95, v8, v22 op_sel_hi:[1,0,0]
    v_fma_mix_f32 v23, v95, v8, v23 op_sel:[1,0,0] op_sel_hi:[1,0,0]
    v_cvt_pk_bf16_f32 v32, v16, v17
    v_cvt_pk_bf16_f32 v33, v18, v19
    v_cvt_pk_bf16_f32 v34, v20, v21
    v_cvt_pk_bf16_f32 v35, v22, v23
    ds_write_b64 v6, v[32:33] offset:128
    ds_write_b64 v6, v[34:35] offset:1152
    v_and_b32 v8, s12, v96
    v_xor_b32 v96, v96, v8
    v_mad_u32_u24 v8, v8, v161, s15
    v_ashrrev_i32 v8, 16, v8
    v_ldexp_f32 v8, 1.0, v8
    v_fma_mix_f32 v16, v96, v8, 0 op_sel_hi:[1,0,0]
    v_fma_mix_f32 v17, v96, v8, 0 op_sel:[1,0,0] op_sel_hi:[1,0,0]
    v_fma_mix_f32 v18, v97, v8, 0 op_sel_hi:[1,0,0]
    v_fma_mix_f32 v19, v97, v8, 0 op_sel:[1,0,0] op_sel_hi:[1,0,0]
    v_fma_mix_f32 v20, v98, v8, 0 op_sel_hi:[1,0,0]
    v_fma_mix_f32 v21, v98, v8, 0 op_sel:[1,0,0] op_sel_hi:[1,0,0]
    v_fma_mix_f32 v22, v99, v8, 0 op_sel_hi:[1,0,0]
    v_fma_mix_f32 v23, v99, v8, 0 op_sel:[1,0,0] op_sel_hi:[1,0,0]
    v_and_b32 v8, s12, v100
    v_xor_b32 v100, v100, v8
    v_mad_u32_u24 v8, v8, v161, s15
    v_ashrrev_i32 v8, 16, v8
    v_ldexp_f32 v8, 1.0, v8
    v_fma_mix_f32 v16, v100, v8, v16 op_sel_hi:[1,0,0]
    v_fma_mix_f32 v17, v100, v8, v17 op_sel:[1,0,0] op_sel_hi:[1,0,0]
    v_fma_mix_f32 v18, v101, v8, v18 op_sel_hi:[1,0,0]
    v_fma_mix_f32 v19, v101, v8, v19 op_sel:[1,0,0] op_sel_hi:[1,0,0]
    v_fma_mix_f32 v20, v102, v8, v20 op_sel_hi:[1,0,0]
    v_fma_mix_f32 v21, v102, v8, v21 op_sel:[1,0,0] op_sel_hi:[1,0,0]
    v_fma_mix_f32 v22, v103, v8, v22 op_sel_hi:[1,0,0]
    v_fma_mix_f32 v23, v103, v8, v23 op_sel:[1,0,0] op_sel_hi:[1,0,0]
    v_and_b32 v8, s12, v104
    v_xor_b32 v104, v104, v8
    v_mad_u32_u24 v8, v8, v161, s15
    v_ashrrev_i32 v8, 16, v8
    v_ldexp_f32 v8, 1.0, v8
    v_fma_mix_f32 v16, v104, v8, v16 op_sel_hi:[1,0,0]
    v_fma_mix_f32 v17, v104, v8, v17 op_sel:[1,0,0] op_sel_hi:[1,0,0]
    v_fma_mix_f32 v18, v105, v8, v18 op_sel_hi:[1,0,0]
    v_fma_mix_f32 v19, v105, v8, v19 op_sel:[1,0,0] op_sel_hi:[1,0,0]
    v_fma_mix_f32 v20, v106, v8, v20 op_sel_hi:[1,0,0]
    v_fma_mix_f32 v21, v106, v8, v21 op_sel:[1,0,0] op_sel_hi:[1,0,0]
    v_fma_mix_f32 v22, v107, v8, v22 op_sel_hi:[1,0,0]
    v_fma_mix_f32 v23, v107, v8, v23 op_sel:[1,0,0] op_sel_hi:[1,0,0]
    v_and_b32 v8, s12, v108
    v_xor_b32 v108, v108, v8
    v_mad_u32_u24 v8, v8, v161, s15
    v_ashrrev_i32 v8, 16, v8
    v_ldexp_f32 v8, 1.0, v8
    v_fma_mix_f32 v16, v108, v8, v16 op_sel_hi:[1,0,0]
    v_fma_mix_f32 v17, v108, v8, v17 op_sel:[1,0,0] op_sel_hi:[1,0,0]
    v_fma_mix_f32 v18, v109, v8, v18 op_sel_hi:[1,0,0]
    v_fma_mix_f32 v19, v109, v8, v19 op_sel:[1,0,0] op_sel_hi:[1,0,0]
    v_fma_mix_f32 v20, v110, v8, v20 op_sel_hi:[1,0,0]
    v_fma_mix_f32 v21, v110, v8, v21 op_sel:[1,0,0] op_sel_hi:[1,0,0]
    v_fma_mix_f32 v22, v111, v8, v22 op_sel_hi:[1,0,0]
    v_fma_mix_f32 v23, v111, v8, v23 op_sel:[1,0,0] op_sel_hi:[1,0,0]
    v_cvt_pk_bf16_f32 v36, v16, v17
    v_cvt_pk_bf16_f32 v37, v18, v19
    v_cvt_pk_bf16_f32 v38, v20, v21
    v_cvt_pk_bf16_f32 v39, v22, v23
    ds_write_b64 v6, v[36:37] offset:192
    ds_write_b64 v6, v[38:39] offset:1216
    s_waitcnt lgkmcnt(0)
    s_mov_b64 exec, 1
    v_mov_b32 v3, 1
    ds_add_u32 v7, v3 offset:4
    s_mov_b64 exec, -1
    s_cmp_lg_u32 s44, 0
    s_cbranch_scc1 L_T3
    s_lshr_b32 s37, s4, 6
    s_lshl_b32 s37, s37, 12
    s_and_b32 s7, s4, 0x38
    s_lshl_b32 s7, s7, 3
    s_add_u32 s37, s37, s7
    s_add_u32 s37, s37, 0x100000
    v_and_b32 v6, 7, v13
    v_lshlrev_b32 v6, 14, v6
    v_lshl_add_u32 v6, v14, 4, v6
    s_cmp_ge_u32 s45, 50
    s_cbranch_scc1 Lo_17
    s_mov_b32 s40, 0
Lw_16:
    ds_read_b32 v3, v7 offset:0
    s_add_u32 s40, s40, 1
    s_waitcnt lgkmcnt(0)
    v_readfirstlane_b32 s45, v3
    s_cmp_ge_u32 s45, 50
    s_cbranch_scc1 Lo_17
    s_sleep 1
    s_cmp_lt_u32 s40, 0x400000
    s_cbranch_scc1 Lw_16
Lo_17:
    s_mov_b32 s40, 0
    s_branch Lp_18
Lr_19:
    s_add_u32 s40, s40, 1
    s_cmp_ge_u32 s40, 40000
    s_cbranch_scc1 Lk_20
    s_sleep 8
Lp_18:
    buffer_load_dwordx4 v[32:35], v6, s[28:31], s37 offen offset:0 sc1
    buffer_load_dwordx4 v[36:39], v6, s[28:31], s37 offen offset:512 sc1
    buffer_load_dwordx4 v[40:43], v6, s[28:31], s37 offen offset:1024 sc1
    buffer_load_dwordx4 v[44:47], v6, s[28:31], s37 offen offset:1536 sc1
    buffer_load_dwordx4 v[48:51], v6, s[28:31], s37 offen offset:2048 sc1
    buffer_load_dwordx4 v[52:55], v6, s[28:31], s37 offen offset:2560 sc1
    buffer_load_dwordx4 v[56:59], v6, s[28:31], s37 offen offset:3072 sc1
    buffer_load_dwordx4 v[60:63], v6, s[28:31], s37 offen offset:3584 sc1
    s_waitcnt vmcnt(0)
    v_xor_b32 v8, s6, v33
    v_bitop3_b32 v8, v8, v35, s6 bitop3:0xf6
    v_bitop3_b32 v8, v8, v37, s6 bitop3:0xf6
    v_bitop3_b32 v8, v8, v39, s6 bitop3:0xf6
    v_bitop3_b32 v8, v8, v41, s6 bitop3:0xf6
    v_bitop3_b32 v8, v8, v43, s6 bitop3:0xf6
    v_bitop3_b32 v8, v8, v45, s6 bitop3:0xf6
    v_bitop3_b32 v8, v8, v47, s6 bitop3:0xf6
    v_bitop3_b32 v8, v8, v49, s6 bitop3:0xf6
    v_bitop3_b32 v8, v8, v51, s6 bitop3:0xf6
    v_bitop3_b32 v8, v8, v53, s6 bitop3:0xf6
    v_bitop3_b32 v8, v8, v55, s6 bitop3:0xf6
    v_bitop3_b32 v8, v8, v57, s6 bitop3:0xf6
    v_bitop3_b32 v8, v8, v59, s6 bitop3:0xf6
    v_bitop3_b32 v8, v8, v61, s6 bitop3:0xf6
    v_bitop3_b32 v8, v8, v63, s6 bitop3:0xf6
    v_cmp_ne_u32 vcc, 0, v8
    s_cbranch_vccnz Lr_19
Lk_20:
    v_max3_f32 v8, v32, v36, v40
    v_max3_f32 v8, v8, v44, v48
    v_max3_f32 v8, v8, v52, v56
    v_max_f32 v8, v8, v60
    v_sub_f32 v16, v32, v8
    v_sub_f32 v17, v36, v8
    v_sub_f32 v18, v40, v8
    v_sub_f32 v19, v44, v8
    v_sub_f32 v20, v48, v8
    v_sub_f32 v21, v52, v8
    v_sub_f32 v22, v56, v8
    v_sub_f32 v23, v60, v8
    v_exp_f32 v16, v16
    v_exp_f32 v17, v17
    v_exp_f32 v18, v18
    v_exp_f32 v19, v19
    v_exp_f32 v20, v20
    v_exp_f32 v21, v21
    v_exp_f32 v22, v22
    v_exp_f32 v23, v23
    s_nop 0
    v_mul_f32 v8, v16, v34
    v_fmac_f32 v8, v17, v38
    v_fmac_f32 v8, v18, v42
    v_fmac_f32 v8, v19, v46
    v_fmac_f32 v8, v20, v50
    v_fmac_f32 v8, v21, v54
    v_fmac_f32 v8, v22, v58
    v_fmac_f32 v8, v23, v62
    v_rcp_f32 v8, v8
    s_nop 0
    v_mul_f32 v16, v16, v8
    v_mul_f32 v17, v17, v8
    v_mul_f32 v18, v18, v8
    v_mul_f32 v19, v19, v8
    v_mul_f32 v20, v20, v8
    v_mul_f32 v21, v21, v8
    v_mul_f32 v22, v22, v8
    v_mul_f32 v23, v23, v8
    v_and_b32 v6, 31, v0
    v_lshlrev_b32 v6, 5, v6
    v_add_u32 v6, 0x26800, v6
    ds_write_b128 v6, v[16:19]
    ds_write_b128 v6, v[20:23] offset:16
    s_waitcnt lgkmcnt(0)
    s_mov_b64 exec, 1
    v_mov_b32 v3, 1
    ds_add_u32 v7, v3 offset:40
    s_mov_b64 exec, -1
    s_branch L_T3
L_A:
    s_setprio 1
    s_cmp_lg_u32 s3, 7
    s_cbranch_scc1 L_notr
    s_lshl_b32 s7, s4, 18
    v_mov_b32 v3, s7
    s_mov_b64 exec, 1
    global_load_dword v16, v3, s[62:63] nt
    global_load_dword v17, v3, s[64:65] nt
    s_mov_b64 exec, -1
L_notr:
    s_mov_b32 s28, s74
    s_mov_b32 s29, s75
    s_mov_b32 s30, 0x10000000
    s_mov_b32 s31, 0x20000
    s_mov_b32 s32, s70
    s_mov_b32 s33, s71
    s_mov_b32 s34, 0x10000
    s_mov_b32 s35, 0x20000
    s_mov_b32 s12, 0x70007
    s_movk_i32 s14, 138
    s_mov_b32 s15, 0xff760000
    s_waitcnt lgkmcnt(0)
    s_add_u32 s6, s6, 0x10001
    s_and_b32 s13, s6, s12
    s_sub_u32 s44, s3, 4
    s_mul_i32 s38, s44, 24576
    v_lshrrev_b32 v8, 5, v0
    v_xor_b32 v8, v8, v2
    v_lshlrev_b32 v8, 4, v8
    v_and_b32 v9, 31, v0
    v_lshl_add_u32 v8, v9, 8, v8
    v_add_u32 v8, s38, v8
    s_add_u32 s57, s44, 1
    s_lshl_b32 s7, s44, 2
    s_waitcnt vmcnt(0)
    v_add_u32 v4, s7, v7
    v_xor_b32 v9, 0x20, v8
    v_xor_b32 v10, 0x40, v8
    v_xor_b32 v11, 0x60, v8
    v_xor_b32 v12, 0x80, v8
    v_xor_b32 v13, 0xa0, v8
    v_xor_b32 v14, 0xc0, v8
    v_xor_b32 v15, 0xe0, v8
    s_cmp_ge_u32 s45, s57
    s_cbranch_scc1 Lo_22
    s_mov_b32 s40, 0
Lw_21:
    ds_read_b32 v3, v7 offset:0
    s_add_u32 s40, s40, 1
    s_waitcnt lgkmcnt(0)
    v_readfirstlane_b32 s45, v3
    s_cmp_ge_u32 s45, s57
    s_cbranch_scc1 Lo_22
    s_sleep 1
    s_cmp_lt_u32 s40, 0x400000
    s_cbranch_scc1 Lw_21
Lo_22:
    s_add_u32 s57, s57, 4
    ds_read_b128 v[64:67], v8 offset:0
    ds_read_b128 v[68:71], v9 offset:0
    ds_read_b128 v[72:75], v10 offset:0
    ds_read_b128 v[76:79], v11 offset:0
    ds_read_b128 v[80:83], v12 offset:0
    ds_read_b128 v[84:87], v13 offset:0
    ds_read_b128 v[88:91], v14 offset:0
    ds_read_b128 v[92:95], v15 offset:0
    s_waitcnt lgkmcnt(0)
    v_mov_b32 v3, 1
    ds_write_b32 v4, v3 offset:16
    s_cmp_ge_u32 s45, s57
    s_cbranch_scc1 Lo_24
    s_mov_b32 s40, 0
Lw_23:
    ds_read_b32 v3, v7 offset:0
    s_add_u32 s40, s40, 1
    s_waitcnt lgkmcnt(0)
    v_readfirstlane_b32 s45, v3
    s_cmp_ge_u32 s45, s57
    s_cbranch_scc1 Lo_24
    s_sleep 1
    s_cmp_lt_u32 s40, 0x400000
    s_cbranch_scc1 Lw_23
Lo_24:
    s_add_u32 s57, s57, 4
    ds_read_b128 v[96:99], v8 offset:8192
    ds_read_b128 v[100:103], v9 offset:8192
    ds_read_b128 v[104:107], v10 offset:8192
    ds_read_b128 v[108:111], v11 offset:8192
    ds_read_b128 v[112:115], v12 offset:8192
    ds_read_b128 v[116:119], v13 offset:8192
    ds_read_b128 v[120:123], v14 offset:8192
    ds_read_b128 v[124:127], v15 offset:8192
    s_waitcnt lgkmcnt(0)
    v_mov_b32 v3, 2
    ds_write_b32 v4, v3 offset:16
    s_cmp_ge_u32 s45, s57
    s_cbranch_scc1 Lo_26
    s_mov_b32 s40, 0
Lw_25:
    ds_read_b32 v3, v7 offset:0
    s_add_u32 s40, s40, 1
    s_waitcnt lgkmcnt(0)
    v_readfirstlane_b32 s45, v3
    s_cmp_ge_u32 s45, s57
    s_cbranch_scc1 Lo_26
    s_sleep 1
    s_cmp_lt_u32 s40, 0x400000
    s_cbranch_scc1 Lw_25
Lo_26:
    s_add_u32 s57, s57, 4
    ds_read_b128 v[128:131], v8 offset:16384
    ds_read_b128 v[132:135], v9 offset:16384
    ds_read_b128 v[136:139], v10 offset:16384
    ds_read_b128 v[140:143], v11 offset:16384
    ds_read_b128 v[144:147], v12 offset:16384
    ds_read_b128 v[148:151], v13 offset:16384
    ds_read_b128 v[152:155], v14 offset:16384
    ds_read_b128 v[156:159], v15 offset:16384
    s_waitcnt lgkmcnt(0)
    v_mov_b32 v3, 3
    ds_write_b32 v4, v3 offset:16
    s_cmp_ge_u32 s45, s57
    s_cbranch_scc1 Lo_28
    s_mov_b32 s40, 0
Lw_27:
    ds_read_b32 v3, v7 offset:0
    s_add_u32 s40, s40, 1
    s_waitcnt lgkmcnt(0)
    v_readfirstlane_b32 s45, v3
    s_cmp_ge_u32 s45, s57
    s_cbranch_scc1 Lo_28
    s_sleep 1
    s_cmp_lt_u32 s40, 0x400000
    s_cbranch_scc1 Lw_27
Lo_28:
    s_add_u32 s57, s57, 4
    ds_read_b128 v[160:163], v8 offset:0
    ds_read_b128 v[164:167], v9 offset:0
    ds_read_b128 v[168:171], v10 offset:0
    ds_read_b128 v[172:175], v11 offset:0
    ds_read_b128 v[176:179], v12 offset:0
    ds_read_b128 v[180:183], v13 offset:0
    ds_read_b128 v[184:187], v14 offset:0
    ds_read_b128 v[188:191], v15 offset:0
    s_waitcnt lgkmcnt(0)
    v_mov_b32 v3, 4
    ds_write_b32 v4, v3 offset:16
    s_cmp_ge_u32 s45, s57
    s_cbranch_scc1 Lo_30
    s_mov_b32 s40, 0
Lw_29:
    ds_read_b32 v3, v7 offset:0
    s_add_u32 s40, s40, 1
    s_waitcnt lgkmcnt(0)
    v_readfirstlane_b32 s45, v3
    s_cmp_ge_u32 s45, s57
    s_cbranch_scc1 Lo_30
    s_sleep 1
    s_cmp_lt_u32 s40, 0x400000
    s_cbranch_scc1 Lw_29
Lo_30:
    s_add_u32 s57, s57, 4
    ds_read_b128 v[192:195], v8 offset:8192
    ds_read_b128 v[196:199], v9 offset:8192
    ds_read_b128 v[200:203], v10 offset:8192
    ds_read_b128 v[204:207], v11 offset:8192
    ds_read_b128 v[208:211], v12 offset:8192
    ds_read_b128 v[212:215], v13 offset:8192
    ds_read_b128 v[216:219], v14 offset:8192
    ds_read_b128 v[220:223], v15 offset:8192
    s_waitcnt lgkmcnt(0)
    v_mov_b32 v3, 5
    ds_write_b32 v4, v3 offset:16
    s_cmp_ge_u32 s45, s57
    s_cbranch_scc1 Lo_32
    s_mov_b32 s40, 0
Lw_31:
    ds_read_b32 v3, v7 offset:0
    s_add_u32 s40, s40, 1
    s_waitcnt lgkmcnt(0)
    v_readfirstlane_b32 s45, v3
    s_cmp_ge_u32 s45, s57
    s_cbranch_scc1 Lo_32
    s_sleep 1
    s_cmp_lt_u32 s40, 0x400000
    s_cbranch_scc1 Lw_31
Lo_32:
    s_add_u32 s57, s57, 4
    ds_read_b128 v[224:227], v8 offset:16384
    ds_read_b128 v[228:231], v9 offset:16384
    ds_read_b128 v[232:235], v10 offset:16384
    ds_read_b128 v[236:239], v11 offset:16384
    ds_read_b128 v[240:243], v12 offset:16384
    ds_read_b128 v[244:247], v13 offset:16384
    ds_read_b128 v[248:251], v14 offset:16384
    ds_read_b128 v[252:255], v15 offset:16384
    s_waitcnt lgkmcnt(0)
    v_mov_b32 v3, 6
    ds_write_b32 v4, v3 offset:16
    s_mov_b32 s40, 0
Lw_33:
    ds_read_b32 v3, v7 offset:4
    s_add_u32 s40, s40, 1
    s_waitcnt lgkmcnt(0)
    v_readfirstlane_b32 s7, v3
    s_cmp_ge_u32 s7, 2
    s_cbranch_scc1 Lo_34
    s_sleep 1
    s_cmp_lt_u32 s40, 0x400000
    s_cbranch_scc1 Lw_33
Lo_34:
    v_add_u32 v6, 0x24000, v5
    ds_read_b128 v[16:19], v6 offset:0
    ds_read_b128 v[20:23], v6 offset:1024
    ds_read_b128 v[24:27], v6 offset:2048
    ds_read_b128 v[28:31], v6 offset:3072
    ds_read_b128 v[32:35], v6 offset:4096
    ds_read_b128 v[36:39], v6 offset:5120
    ds_read_b128 v[40:43], v6 offset:6144
    ds_read_b128 v[44:47], v6 offset:7168
    s_waitcnt lgkmcnt(0)
    v_mfma_f32_32x32x16_bf16 v[48:63], v[64:67], v[16:19], 0
    v_mfma_f32_32x32x16_bf16 v[48:63], v[68:71], v[20:23], v[48:63]
    v_mfma_f32_32x32x16_bf16 v[48:63], v[72:75], v[24:27], v[48:63]
    v_mfma_f32_32x32x16_bf16 v[48:63], v[76:79], v[28:31], v[48:63]
    v_mfma_f32_32x32x16_bf16 v[48:63], v[80:83], v[32:35], v[48:63]
    v_mfma_f32_32x32x16_bf16 v[48:63], v[84:87], v[36:39], v[48:63]
    v_mfma_f32_32x32x16_bf16 v[48:63], v[88:91], v[40:43], v[48:63]
    v_mfma_f32_32x32x16_bf16 v[48:63], v[92:95], v[44:47], v[48:63]
    v_mfma_f32_32x32x16_bf16 v[64:79], v[96:99], v[16:19], 0
    v_mfma_f32_32x32x16_bf16 v[64:79], v[100:103], v[20:23], v[64:79]
    v_mfma_f32_32x32x16_bf16 v[64:79], v[104:107], v[24:27], v[64:79]
    v_mfma_f32_32x32x16_bf16 v[64:79], v[108:111], v[28:31], v[64:79]
    v_mfma_f32_32x32x16_bf16 v[64:79], v[112:115], v[32:35], v[64:79]
    v_mfma_f32_32x32x16_bf16 v[64:79], v[116:119], v[36:39], v[64:79]
    v_mfma_f32_32x32x16_bf16 v[64:79], v[120:123], v[40:43], v[64:79]
    v_mfma_f32_32x32x16_bf16 v[64:79], v[124:127], v[44:47], v[64:79]
    v_mfma_f32_32x32x16_bf16 v[80:95], v[128:131], v[16:19], 0
    v_mfma_f32_32x32x16_bf16 v[80:95], v[132:135], v[20:23], v[80:95]
    v_mfma_f32_32x32x16_bf16 v[80:95], v[136:139], v[24:27], v[80:95]
    v_mfma_f32_32x32x16_bf16 v[80:95], v[140:143], v[28:31], v[80:95]
    v_mfma_f32_32x32x16_bf16 v[80:95], v[144:147], v[32:35], v[80:95]
    v_mfma_f32_32x32x16_bf16 v[80:95], v[148:151], v[36:39], v[80:95]
    v_mfma_f32_32x32x16_bf16 v[80:95], v[152:155], v[40:43], v[80:95]
    v_mfma_f32_32x32x16_bf16 v[80:95], v[156:159], v[44:47], v[80:95]
    v_mfma_f32_32x32x16_bf16 v[96:111], v[160:163], v[16:19], 0
    v_mfma_f32_32x32x16_bf16 v[96:111], v[164:167], v[20:23], v[96:111]
    v_mfma_f32_32x32x16_bf16 v[96:111], v[168:171], v[24:27], v[96:111]
    v_mfma_f32_32x32x16_bf16 v[96:111], v[172:175], v[28:31], v[96:111]
    v_mfma_f32_32x32x16_bf16 v[96:111], v[176:179], v[32:35], v[96:111]
    v_mfma_f32_32x32x16_bf16 v[96:111], v[180:183], v[36:39], v[96:111]
    v_mfma_f32_32x32x16_bf16 v[96:111], v[184:187], v[40:43], v[96:111]
    v_mfma_f32_32x32x16_bf16 v[96:111], v[188:191], v[44:47], v[96:111]
    v_mfma_f32_32x32x16_bf16 v[112:127], v[192:195], v[16:19], 0
    v_mfma_f32_32x32x16_bf16 v[112:127], v[196:199], v[20:23], v[112:127]
    v_mfma_f32_32x32x16_bf16 v[112:127], v[200:203], v[24:27], v[112:127]
    v_mfma_f32_32x32x16_bf16 v[112:127], v[204:207], v[28:31], v[112:127]
    v_mfma_f32_32x32x16_bf16 v[112:127], v[208:211], v[32:35], v[112:127]
    v_mfma_f32_32x32x16_bf16 v[112:127], v[212:215], v[36:39], v[112:127]
    v_mfma_f32_32x32x16_bf16 v[112:127], v[216:219], v[40:43], v[112:127]
    v_mfma_f32_32x32x16_bf16 v[112:127], v[220:223], v[44:47], v[112:127]
    s_cmp_ge_u32 s45, s57
    s_cbranch_scc1 Lo_36
    s_mov_b32 s40, 0
Lw_35:
    ds_read_b32 v3, v7 offset:0
    s_add_u32 s40, s40, 1
    s_waitcnt lgkmcnt(0)
    v_readfirstlane_b32 s45, v3
    s_cmp_ge_u32 s45, s57
    s_cbranch_scc1 Lo_36
    s_sleep 1
    s_cmp_lt_u32 s40, 0x400000
    s_cbranch_scc1 Lw_35
Lo_36:
    s_add_u32 s57, s57, 4
    ds_read_b128 v[192:195], v8 offset:0
    ds_read_b128 v[196:199], v9 offset:0
    ds_read_b128 v[200:203], v10 offset:0
    ds_read_b128 v[204:207], v11 offset:0
    ds_read_b128 v[208:211], v12 offset:0
    ds_read_b128 v[212:215], v13 offset:0
    ds_read_b128 v[216:219], v14 offset:0
    ds_read_b128 v[220:223], v15 offset:0
    s_waitcnt lgkmcnt(0)
    v_mov_b32 v3, 7
    ds_write_b32 v4, v3 offset:16
    v_mfma_f32_32x32x16_bf16 v[128:143], v[224:227], v[16:19], 0
    v_mfma_f32_32x32x16_bf16 v[128:143], v[228:231], v[20:23], v[128:143]
    v_mfma_f32_32x32x16_bf16 v[128:143], v[232:235], v[24:27], v[128:143]
    v_mfma_f32_32x32x16_bf16 v[128:143], v[236:239], v[28:31], v[128:143]
    v_mfma_f32_32x32x16_bf16 v[128:143], v[240:243], v[32:35], v[128:143]
    v_mfma_f32_32x32x16_bf16 v[128:143], v[244:247], v[36:39], v[128:143]
    v_mfma_f32_32x32x16_bf16 v[128:143], v[248:251], v[40:43], v[128:143]
    v_mfma_f32_32x32x16_bf16 v[128:143], v[252:255], v[44:47], v[128:143]
    s_cmp_ge_u32 s45, s57
    s_cbranch_scc1 Lo_38
    s_mov_b32 s40, 0
Lw_37:
    ds_read_b32 v3, v7 offset:0
    s_add_u32 s40, s40, 1
    s_waitcnt lgkmcnt(0)
    v_readfirstlane_b32 s45, v3
    s_cmp_ge_u32 s45, s57
    s_cbranch_scc1 Lo_38
    s_sleep 1
    s_cmp_lt_u32 s40, 0x400000
    s_cbranch_scc1 Lw_37
Lo_38:
    s_add_u32 s57, s57, 4
    ds_read_b128 v[224:227], v8 offset:8192
    ds_read_b128 v[228:231], v9 offset:8192
    ds_read_b128 v[232:235], v10 offset:8192
    ds_read_b128 v[236:239], v11 offset:8192
    ds_read_b128 v[240:243], v12 offset:8192
    ds_read_b128 v[244:247], v13 offset:8192
    ds_read_b128 v[248:251], v14 offset:8192
    ds_read_b128 v[252:255], v15 offset:8192
    s_waitcnt lgkmcnt(0)
    v_mov_b32 v3, 8
    ds_write_b32 v4, v3 offset:16
    v_mfma_f32_32x32x16_bf16 v[144:159], v[192:195], v[16:19], 0
    v_mfma_f32_32x32x16_bf16 v[144:159], v[196:199], v[20:23], v[144:159]
    v_mfma_f32_32x32x16_bf16 v[144:159], v[200:203], v[24:27], v[144:159]
    v_mfma_f32_32x32x16_bf16 v[144:159], v[204:207], v[28:31], v[144:159]
    v_mfma_f32_32x32x16_bf16 v[144:159], v[208:211], v[32:35], v[144:159]
    v_mfma_f32_32x32x16_bf16 v[144:159], v[212:215], v[36:39], v[144:159]
    v_mfma_f32_32x32x16_bf16 v[144:159], v[216:219], v[40:43], v[144:159]
    v_mfma_f32_32x32x16_bf16 v[144:159], v[220:223], v[44:47], v[144:159]
    v_mfma_f32_32x32x16_bf16 v[160:175], v[224:227], v[16:19], 0
    v_mfma_f32_32x32x16_bf16 v[160:175], v[228:231], v[20:23], v[160:175]
    v_mfma_f32_32x32x16_bf16 v[160:175], v[232:235], v[24:27], v[160:175]
    v_mfma_f32_32x32x16_bf16 v[160:175], v[236:239], v[28:31], v[160:175]
    v_mfma_f32_32x32x16_bf16 v[160:175], v[240:243], v[32:35], v[160:175]
    v_mfma_f32_32x32x16_bf16 v[160:175], v[244:247], v[36:39], v[160:175]
    v_mfma_f32_32x32x16_bf16 v[160:175], v[248:251], v[40:43], v[160:175]
    v_mfma_f32_32x32x16_bf16 v[160:175], v[252:255], v[44:47], v[160:175]
    v_lshrrev_b32 v12, 2, v2
    v_lshrrev_b32 v13, 5, v0
    v_lshl_add_u32 v13, v13, 2, v12
    v_lshlrev_b32 v8, 8, v13
    v_lshl_add_u32 v8, v12, 6, v8
    v_and_b32 v13, 1, v1
    v_lshl_add_u32 v8, v13, 5, v8
    v_and_b32 v13, 3, v0
    v_lshl_add_u32 v8, v13, 3, v8
    s_lshl_b32 s7, s44, 6
    s_add_u32 s7, s7, s38
    v_xor_b32 v8, s7, v8
    v_xor_b32 v9, 64, v8
    v_xor_b32 v10, 0x80, v8
    v_xor_b32 v11, 0xc0, v8
    s_mov_b32 s41, 0x3e0293ee
    v_max3_f32 v12, v48, v49, v50
    v_max3_f32 v13, v51, v52, v53
    v_max3_f32 v12, v12, v54, v55
    v_max3_f32 v13, v13, v56, v57
    v_max3_f32 v12, v12, v58, v59
    v_max3_f32 v13, v13, v60, v61
    v_max3_f32 v12, v12, v62, v63
    v_max3_f32 v13, v13, v64, v65
    v_max3_f32 v12, v12, v66, v67
    v_max3_f32 v13, v13, v68, v69
    v_max3_f32 v12, v12, v70, v71
    v_max3_f32 v13, v13, v72, v73
    v_max3_f32 v12, v12, v74, v75
    v_max3_f32 v13, v13, v76, v77
    v_max3_f32 v12, v12, v78, v79
    v_max3_f32 v13, v13, v80, v81
    v_max3_f32 v12, v12, v82, v83
    v_max3_f32 v13, v13, v84, v85
    v_max3_f32 v12, v12, v86, v87
    v_max3_f32 v13, v13, v88, v89
    v_max3_f32 v12, v12, v90, v91
    v_max3_f32 v13, v13, v92, v93
    v_max3_f32 v12, v12, v94, v95
    v_max3_f32 v13, v13, v96, v97
    v_max3_f32 v12, v12, v98, v99
    v_max3_f32 v13, v13, v100, v101
    v_max3_f32 v12, v12, v102, v103
    v_max3_f32 v13, v13, v104, v105
    v_max3_f32 v12, v12, v106, v107
    v_max3_f32 v13, v13, v108, v109
    v_max3_f32 v12, v12, v110, v111
    v_max3_f32 v13, v13, v112, v113
    v_max3_f32 v12, v12, v114, v115
    v_max3_f32 v13, v13, v116, v117
    v_max3_f32 v12, v12, v118, v119
    v_max3_f32 v13, v13, v120, v121
    v_max3_f32 v12, v12, v122, v123
    v_max3_f32 v13, v13, v124, v125
    v_max3_f32 v12, v12, v126, v127
    v_max3_f32 v13, v13, v128, v129
    v_max3_f32 v12, v12, v130, v131
    v_max3_f32 v13, v13, v132, v133
    v_max3_f32 v12, v12, v134, v135
    v_max3_f32 v13, v13, v136, v137
    v_max3_f32 v12, v12, v138, v139
    v_max3_f32 v13, v13, v140, v141
    v_max3_f32 v12, v12, v142, v143
    v_max3_f32 v13, v13, v144, v145
    v_max3_f32 v12, v12, v146, v147
    v_max3_f32 v13, v13, v148, v149
    v_max3_f32 v12, v12, v150, v151
    v_max3_f32 v13, v13, v152, v153
    v_max3_f32 v12, v12, v154, v155
    v_max3_f32 v13, v13, v156, v157
    v_max3_f32 v12, v12, v158, v159
    v_max3_f32 v13, v13, v160, v161
    v_max3_f32 v12, v12, v162, v163
    v_max3_f32 v13, v13, v164, v165
    v_max3_f32 v12, v12, v166, v167
    v_max3_f32 v13, v13, v168, v169
    v_max3_f32 v12, v12, v170, v171
    v_max3_f32 v13, v13, v172, v173
    v_max3_f32 v12, v12, v174, v175
    v_max_f32 v12, v12, v13
    v_mov_b32 v13, v12
    s_nop 1
    v_permlane32_swap_b32 v12, v13
    v_max_f32 v12, v12, v13
    v_mul_f32 v12, s41, v12
    v_mov_b32 v14, 0
    v_mov_b32 v15, 0
    v_fma_f32 v48, v48, s41, -v12
    v_fma_f32 v49, v49, s41, -v12
    v_fma_f32 v50, v50, s41, -v12
    v_fma_f32 v51, v51, s41, -v12
    v_exp_f32 v48, v48
    v_exp_f32 v49, v49
    v_exp_f32 v50, v50
    v_exp_f32 v51, v51
    v_fma_f32 v52, v52, s41, -v12
    v_fma_f32 v53, v53, s41, -v12
    v_fma_f32 v54, v54, s41, -v12
    v_fma_f32 v55, v55, s41, -v12
    v_exp_f32 v52, v52
    v_exp_f32 v53, v53
    v_exp_f32 v54, v54
    v_exp_f32 v55, v55
    v_add_f32 v14, v14, v48
    v_add_f32 v15, v15, v49
    v_add_f32 v14, v14, v50
    v_add_f32 v15, v15, v51
    v_cvt_pk_bf16_f32 v48, v48, v49
    v_cvt_pk_bf16_f32 v49, v50, v51
    v_fma_f32 v56, v56, s41, -v12
    v_fma_f32 v57, v57, s41, -v12
    v_fma_f32 v58, v58, s41, -v12
    v_fma_f32 v59, v59, s41, -v12
    v_exp_f32 v56, v56
    v_exp_f32 v57, v57
    v_exp_f32 v58, v58
    v_exp_f32 v59, v59
    v_add_f32 v14, v14, v52
    v_add_f32 v15, v15, v53
    v_add_f32 v14, v14, v54
    v_add_f32 v15, v15, v55
    v_cvt_pk_bf16_f32 v50, v52, v53
    v_cvt_pk_bf16_f32 v51, v54, v55
    v_fma_f32 v60, v60, s41, -v12
    v_fma_f32 v61, v61, s41, -v12
    v_fma_f32 v62, v62, s41, -v12
    v_fma_f32 v63, v63, s41, -v12
    v_exp_f32 v60, v60
    v_exp_f32 v61, v61
    v_exp_f32 v62, v62
    v_exp_f32 v63, v63
    v_add_f32 v14, v14, v56
    v_add_f32 v15, v15, v57
    v_add_f32 v14, v14, v58
    v_add_f32 v15, v15, v59
    v_cvt_pk_bf16_f32 v52, v56, v57
    v_cvt_pk_bf16_f32 v53, v58, v59
    v_fma_f32 v64, v64, s41, -v12
    v_fma_f32 v65, v65, s41, -v12
    v_fma_f32 v66, v66, s41, -v12
    v_fma_f32 v67, v67, s41, -v12
    v_exp_f32 v64, v64
    v_exp_f32 v65, v65
    v_exp_f32 v66, v66
    v_exp_f32 v67, v67
    v_add_f32 v14, v14, v60
    v_add_f32 v15, v15, v61
    v_add_f32 v14, v14, v62
    v_add_f32 v15, v15, v63
    v_cvt_pk_bf16_f32 v54, v60, v61
    v_cvt_pk_bf16_f32 v55, v62, v63
    v_fma_f32 v68, v68, s41, -v12
    v_fma_f32 v69, v69, s41, -v12
    v_fma_f32 v70, v70, s41, -v12
    v_fma_f32 v71, v71, s41, -v12
    v_exp_f32 v68, v68
    v_exp_f32 v69, v69
    v_exp_f32 v70, v70
    v_exp_f32 v71, v71
    v_add_f32 v14, v14, v64
    v_add_f32 v15, v15, v65
    v_add_f32 v14, v14, v66
    v_add_f32 v15, v15, v67
    v_cvt_pk_bf16_f32 v56, v64, v65
    v_cvt_pk_bf16_f32 v57, v66, v67
    v_fma_f32 v72, v72, s41, -v12
    v_fma_f32 v73, v73, s41, -v12
    v_fma_f32 v74, v74, s41, -v12
    v_fma_f32 v75, v75, s41, -v12
    v_exp_f32 v72, v72
    v_exp_f32 v73, v73
    v_exp_f32 v74, v74
    v_exp_f32 v75, v75
    v_add_f32 v14, v14, v68
    v_add_f32 v15, v15, v69
    v_add_f32 v14, v14, v70
    v_add_f32 v15, v15, v71
    v_cvt_pk_bf16_f32 v58, v68, v69
    v_cvt_pk_bf16_f32 v59, v70, v71
    v_fma_f32 v76, v76, s41, -v12
    v_fma_f32 v77, v77, s41, -v12
    v_fma_f32 v78, v78, s41, -v12
    v_fma_f32 v79, v79, s41, -v12
    v_exp_f32 v76, v76
    v_exp_f32 v77, v77
    v_exp_f32 v78, v78
    v_exp_f32 v79, v79
    v_add_f32 v14, v14, v72
    v_add_f32 v15, v15, v73
    v_add_f32 v14, v14, v74
    v_add_f32 v15, v15, v75
    v_cvt_pk_bf16_f32 v60, v72, v73
    v_cvt_pk_bf16_f32 v61, v74, v75
    v_fma_f32 v80, v80, s41, -v12
    v_fma_f32 v81, v81, s41, -v12
    v_fma_f32 v82, v82, s41, -v12
    v_fma_f32 v83, v83, s41, -v12
    v_exp_f32 v80, v80
    v_exp_f32 v81, v81
    v_exp_f32 v82, v82
    v_exp_f32 v83, v83
    v_add_f32 v14, v14, v76
    v_add_f32 v15, v15, v77
    v_add_f32 v14, v14, v78
    v_add_f32 v15, v15, v79
    v_cvt_pk_bf16_f32 v62, v76, v77
    v_cvt_pk_bf16_f32 v63, v78, v79
    v_fma_f32 v84, v84, s41, -v12
    v_fma_f32 v85, v85, s41, -v12
    v_fma_f32 v86, v86, s41, -v12
    v_fma_f32 v87, v87, s41, -v12
    v_exp_f32 v84, v84
    v_exp_f32 v85, v85
    v_exp_f32 v86, v86
    v_exp_f32 v87, v87
    v_add_f32 v14, v14, v80
    v_add_f32 v15, v15, v81
    v_add_f32 v14, v14, v82
    v_add_f32 v15, v15, v83
    v_cvt_pk_bf16_f32 v64, v80, v81
    v_cvt_pk_bf16_f32 v65, v82, v83
    v_fma_f32 v88, v88, s41, -v12
    v_fma_f32 v89, v89, s41, -v12
    v_fma_f32 v90, v90, s41, -v12
    v_fma_f32 v91, v91, s41, -v12
    v_exp_f32 v88, v88
    v_exp_f32 v89, v89
    v_exp_f32 v90, v90
    v_exp_f32 v91, v91
    v_add_f32 v14, v14, v84
    v_add_f32 v15, v15, v85
    v_add_f32 v14, v14, v86
    v_add_f32 v15, v15, v87
    v_cvt_pk_bf16_f32 v66, v84, v85
    v_cvt_pk_bf16_f32 v67, v86, v87
    v_fma_f32 v92, v92, s41, -v12
    v_fma_f32 v93, v93, s41, -v12
    v_fma_f32 v94, v94, s41, -v12
    v_fma_f32 v95, v95, s41, -v12
    v_exp_f32 v92, v92
    v_exp_f32 v93, v93
    v_exp_f32 v94, v94
    v_exp_f32 v95, v95
    v_add_f32 v14, v14, v88
    v_add_f32 v15, v15, v89
    v_add_f32 v14, v14, v90
    v_add_f32 v15, v15, v91
    v_cvt_pk_bf16_f32 v68, v88, v89
    v_cvt_pk_bf16_f32 v69, v90, v91
    v_fma_f32 v96, v96, s41, -v12
    v_fma_f32 v97, v97, s41, -v12
    v_fma_f32 v98, v98, s41, -v12
    v_fma_f32 v99, v99, s41, -v12
    v_exp_f32 v96, v96
    v_exp_f32 v97, v97
    v_exp_f32 v98, v98
    v_exp_f32 v99, v99
    v_add_f32 v14, v14, v92
    v_add_f32 v15, v15, v93
    v_add_f32 v14, v14, v94
    v_add_f32 v15, v15, v95
    v_cvt_pk_bf16_f32 v70, v92, v93
    v_cvt_pk_bf16_f32 v71, v94, v95
    v_fma_f32 v100, v100, s41, -v12
    v_fma_f32 v101, v101, s41, -v12
    v_fma_f32 v102, v102, s41, -v12
    v_fma_f32 v103, v103, s41, -v12
    v_exp_f32 v100, v100
    v_exp_f32 v101, v101
    v_exp_f32 v102, v102
    v_exp_f32 v103, v103
    v_add_f32 v14, v14, v96
    v_add_f32 v15, v15, v97
    v_add_f32 v14, v14, v98
    v_add_f32 v15, v15, v99
    v_cvt_pk_bf16_f32 v72, v96, v97
    v_cvt_pk_bf16_f32 v73, v98, v99
    v_fma_f32 v104, v104, s41, -v12
    v_fma_f32 v105, v105, s41, -v12
    v_fma_f32 v106, v106, s41, -v12
    v_fma_f32 v107, v107, s41, -v12
    v_exp_f32 v104, v104
    v_exp_f32 v105, v105
    v_exp_f32 v106, v106
    v_exp_f32 v107, v107
    v_add_f32 v14, v14, v100
    v_add_f32 v15, v15, v101
    v_add_f32 v14, v14, v102
    v_add_f32 v15, v15, v103
    v_cvt_pk_bf16_f32 v74, v100, v101
    v_cvt_pk_bf16_f32 v75, v102, v103
    v_fma_f32 v108, v108, s41, -v12
    v_fma_f32 v109, v109, s41, -v12
    v_fma_f32 v110, v110, s41, -v12
    v_fma_f32 v111, v111, s41, -v12
    v_exp_f32 v108, v108
    v_exp_f32 v109, v109
    v_exp_f32 v110, v110
    v_exp_f32 v111, v111
    v_add_f32 v14, v14, v104
    v_add_f32 v15, v15, v105
    v_add_f32 v14, v14, v106
    v_add_f32 v15, v15, v107
    v_cvt_pk_bf16_f32 v76, v104, v105
    v_cvt_pk_bf16_f32 v77, v106, v107
    v_fma_f32 v112, v112, s41, -v12
    v_fma_f32 v113, v113, s41, -v12
    v_fma_f32 v114, v114, s41, -v12
    v_fma_f32 v115, v115, s41, -v12
    v_exp_f32 v112, v112
    v_exp_f32 v113, v113
    v_exp_f32 v114, v114
    v_exp_f32 v115, v115
    v_add_f32 v14, v14, v108
    v_add_f32 v15, v15, v109
    v_add_f32 v14, v14, v110
    v_add_f32 v15, v15, v111
    v_cvt_pk_bf16_f32 v78, v108, v109
    v_cvt_pk_bf16_f32 v79, v110, v111
    v_fma_f32 v116, v116, s41, -v12
    v_fma_f32 v117, v117, s41, -v12
    v_fma_f32 v118, v118, s41, -v12
    v_fma_f32 v119, v119, s41, -v12
    v_exp_f32 v116, v116
    v_exp_f32 v117, v117
    v_exp_f32 v118, v118
    v_exp_f32 v119, v119
    v_add_f32 v14, v14, v112
    v_add_f32 v15, v15, v113
    v_add_f32 v14, v14, v114
    v_add_f32 v15, v15, v115
    v_cvt_pk_bf16_f32 v80, v112, v113
    v_cvt_pk_bf16_f32 v81, v114, v115
    v_fma_f32 v120, v120, s41, -v12
    v_fma_f32 v121, v121, s41, -v12
    v_fma_f32 v122, v122, s41, -v12
    v_fma_f32 v123, v123, s41, -v12
    v_exp_f32 v120, v120
    v_exp_f32 v121, v121
    v_exp_f32 v122, v122
    v_exp_f32 v123, v123
    v_add_f32 v14, v14, v116
    v_add_f32 v15, v15, v117
    v_add_f32 v14, v14, v118
    v_add_f32 v15, v15, v119
    v_cvt_pk_bf16_f32 v82, v116, v117
    v_cvt_pk_bf16_f32 v83, v118, v119
    v_fma_f32 v124, v124, s41, -v12
    v_fma_f32 v125, v125, s41, -v12
    v_fma_f32 v126, v126, s41, -v12
    v_fma_f32 v127, v127, s41, -v12
    v_exp_f32 v124, v124
    v_exp_f32 v125, v125
    v_exp_f32 v126, v126
    v_exp_f32 v127, v127
    v_add_f32 v14, v14, v120
    v_add_f32 v15, v15, v121
    v_add_f32 v14, v14, v122
    v_add_f32 v15, v15, v123
    v_cvt_pk_bf16_f32 v84, v120, v121
    v_cvt_pk_bf16_f32 v85, v122, v123
    v_fma_f32 v128, v128, s41, -v12
    v_fma_f32 v129, v129, s41, -v12
    v_fma_f32 v130, v130, s41, -v12
    v_fma_f32 v131, v131, s41, -v12
    v_exp_f32 v128, v128
    v_exp_f32 v129, v129
    v_exp_f32 v130, v130
    v_exp_f32 v131, v131
    v_add_f32 v14, v14, v124
    v_add_f32 v15, v15, v125
    v_add_f32 v14, v14, v126
    v_add_f32 v15, v15, v127
    v_cvt_pk_bf16_f32 v86, v124, v125
    v_cvt_pk_bf16_f32 v87, v126, v127
    v_fma_f32 v132, v132, s41, -v12
    v_fma_f32 v133, v133, s41, -v12
    v_fma_f32 v134, v134, s41, -v12
    v_fma_f32 v135, v135, s41, -v12
    v_exp_f32 v132, v132
    v_exp_f32 v133, v133
    v_exp_f32 v134, v134
    v_exp_f32 v135, v135
    v_add_f32 v14, v14, v128
    v_add_f32 v15, v15, v129
    v_add_f32 v14, v14, v130
    v_add_f32 v15, v15, v131
    v_cvt_pk_bf16_f32 v88, v128, v129
    v_cvt_pk_bf16_f32 v89, v130, v131
    v_fma_f32 v136, v136, s41, -v12
    v_fma_f32 v137, v137, s41, -v12
    v_fma_f32 v138, v138, s41, -v12
    v_fma_f32 v139, v139, s41, -v12
    v_exp_f32 v136, v136
    v_exp_f32 v137, v137
    v_exp_f32 v138, v138
    v_exp_f32 v139, v139
    v_add_f32 v14, v14, v132
    v_add_f32 v15, v15, v133
    v_add_f32 v14, v14, v134
    v_add_f32 v15, v15, v135
    v_cvt_pk_bf16_f32 v90, v132, v133
    v_cvt_pk_bf16_f32 v91, v134, v135
    v_fma_f32 v140, v140, s41, -v12
    v_fma_f32 v141, v141, s41, -v12
    v_fma_f32 v142, v142, s41, -v12
    v_fma_f32 v143, v143, s41, -v12
    v_exp_f32 v140, v140
    v_exp_f32 v141, v141
    v_exp_f32 v142, v142
    v_exp_f32 v143, v143
    v_add_f32 v14, v14, v136
    v_add_f32 v15, v15, v137
    v_add_f32 v14, v14, v138
    v_add_f32 v15, v15, v139
    v_cvt_pk_bf16_f32 v92, v136, v137
    v_cvt_pk_bf16_f32 v93, v138, v139
    v_fma_f32 v144, v144, s41, -v12
    v_fma_f32 v145, v145, s41, -v12
    v_fma_f32 v146, v146, s41, -v12
    v_fma_f32 v147, v147, s41, -v12
    v_exp_f32 v144, v144
    v_exp_f32 v145, v145
    v_exp_f32 v146, v146
    v_exp_f32 v147, v147
    v_add_f32 v14, v14, v140
    v_add_f32 v15, v15, v141
    v_add_f32 v14, v14, v142
    v_add_f32 v15, v15, v143
    v_cvt_pk_bf16_f32 v94, v140, v141
    v_cvt_pk_bf16_f32 v95, v142, v143
    v_fma_f32 v148, v148, s41, -v12
    v_fma_f32 v149, v149, s41, -v12
    v_fma_f32 v150, v150, s41, -v12
    v_fma_f32 v151, v151, s41, -v12
    v_exp_f32 v148, v148
    v_exp_f32 v149, v149
    v_exp_f32 v150, v150
    v_exp_f32 v151, v151
    v_add_f32 v14, v14, v144
    v_add_f32 v15, v15, v145
    v_add_f32 v14, v14, v146
    v_add_f32 v15, v15, v147
    v_cvt_pk_bf16_f32 v96, v144, v145
    v_cvt_pk_bf16_f32 v97, v146, v147
    v_fma_f32 v152, v152, s41, -v12
    v_fma_f32 v153, v153, s41, -v12
    v_fma_f32 v154, v154, s41, -v12
    v_fma_f32 v155, v155, s41, -v12
    v_exp_f32 v152, v152
    v_exp_f32 v153, v153
    v_exp_f32 v154, v154
    v_exp_f32 v155, v155
    v_add_f32 v14, v14, v148
    v_add_f32 v15, v15, v149
    v_add_f32 v14, v14, v150
    v_add_f32 v15, v15, v151
    v_cvt_pk_bf16_f32 v98, v148, v149
    v_cvt_pk_bf16_f32 v99, v150, v151
    v_fma_f32 v156, v156, s41, -v12
    v_fma_f32 v157, v157, s41, -v12
    v_fma_f32 v158, v158, s41, -v12
    v_fma_f32 v159, v159, s41, -v12
    v_exp_f32 v156, v156
    v_exp_f32 v157, v157
    v_exp_f32 v158, v158
    v_exp_f32 v159, v159
    v_add_f32 v14, v14, v152
    v_add_f32 v15, v15, v153
    v_add_f32 v14, v14, v154
    v_add_f32 v15, v15, v155
    v_cvt_pk_bf16_f32 v100, v152, v153
    v_cvt_pk_bf16_f32 v101, v154, v155
    v_fma_f32 v160, v160, s41, -v12
    v_fma_f32 v161, v161, s41, -v12
    v_fma_f32 v162, v162, s41, -v12
    v_fma_f32 v163, v163, s41, -v12
    v_exp_f32 v240, v160
    v_exp_f32 v241, v161
    v_exp_f32 v242, v162
    v_exp_f32 v243, v163
    v_add_f32 v14, v14, v156
    v_add_f32 v15, v15, v157
    v_add_f32 v14, v14, v158
    v_add_f32 v15, v15, v159
    v_cvt_pk_bf16_f32 v102, v156, v157
    v_cvt_pk_bf16_f32 v103, v158, v159
    v_fma_f32 v164, v164, s41, -v12
    v_fma_f32 v165, v165, s41, -v12
    v_fma_f32 v166, v166, s41, -v12
    v_fma_f32 v167, v167, s41, -v12
    v_exp_f32 v244, v164
    v_exp_f32 v245, v165
    v_exp_f32 v246, v166
    v_exp_f32 v247, v167
    v_add_f32 v14, v14, v240
    v_add_f32 v15, v15, v241
    v_add_f32 v14, v14, v242
    v_add_f32 v15, v15, v243
    v_fma_f32 v168, v168, s41, -v12
    v_fma_f32 v169, v169, s41, -v12
    v_fma_f32 v170, v170, s41, -v12
    v_fma_f32 v171, v171, s41, -v12
    v_exp_f32 v248, v168
    v_exp_f32 v249, v169
    v_exp_f32 v250, v170
    v_exp_f32 v251, v171
    v_add_f32 v14, v14, v244
    v_add_f32 v15, v15, v245
    v_add_f32 v14, v14, v246
    v_add_f32 v15, v15, v247
    v_fma_f32 v172, v172, s41, -v12
    v_fma_f32 v173, v173, s41, -v12
    v_fma_f32 v174, v174, s41, -v12
    v_fma_f32 v175, v175, s41, -v12
    v_exp_f32 v252, v172
    v_exp_f32 v253, v173
    v_exp_f32 v254, v174
    v_exp_f32 v255, v175
    v_add_f32 v14, v14, v248
    v_add_f32 v15, v15, v249
    v_add_f32 v14, v14, v250
    v_add_f32 v15, v15, v251
    s_nop 0
    v_add_f32 v14, v14, v252
    v_add_f32 v15, v15, v253
    v_add_f32 v14, v14, v254
    v_add_f32 v15, v15, v255
    v_add_f32 v14, v14, v15
    v_mov_b32 v15, v14
    v_and_b32 v3, 31, v0
    v_lshlrev_b32 v3, 3, v3
    v_permlane32_swap_b32 v14, v15
    s_lshl_b32 s7, s44, 8
    s_add_u32 s7, s7, 0x26000
    v_add_f32 v13, v14, v15
    v_add_u32 v3, s7, v3
    ds_write_b64 v3, v[12:13]
    s_waitcnt lgkmcnt(0)
    s_mov_b64 exec, 1
    v_mov_b32 v3, 1
    ds_add_u32 v7, v3 offset:8
    s_mov_b64 exec, -1
    s_cmp_ge_u32 s45, s57
    s_cbranch_scc1 Lo_40
    s_mov_b32 s40, 0
Lw_39:
    ds_read_b32 v3, v7 offset:0
    s_add_u32 s40, s40, 1
    s_waitcnt lgkmcnt(0)
    v_readfirstlane_b32 s45, v3
    s_cmp_ge_u32 s45, s57
    s_cbranch_scc1 Lo_40
    s_sleep 1
    s_cmp_lt_u32 s40, 0x400000
    s_cbranch_scc1 Lw_39
Lo_40:
    s_add_u32 s57, s57, 4
    ds_read_b64_tr_b16 v[176:177], v8 offset:16384
    ds_read_b64_tr_b16 v[178:179], v8 offset:18432
    ds_read_b64_tr_b16 v[180:181], v9 offset:16384
    ds_read_b64_tr_b16 v[182:183], v9 offset:18432
    ds_read_b64_tr_b16 v[184:185], v10 offset:16384
    ds_read_b64_tr_b16 v[186:187], v10 offset:18432
    ds_read_b64_tr_b16 v[188:189], v11 offset:16384
    ds_read_b64_tr_b16 v[190:191], v11 offset:18432
    ds_read_b64_tr_b16 v[192:193], v8 offset:20480
    ds_read_b64_tr_b16 v[194:195], v8 offset:22528
    ds_read_b64_tr_b16 v[196:197], v9 offset:20480
    ds_read_b64_tr_b16 v[198:199], v9 offset:22528
    ds_read_b64_tr_b16 v[200:201], v10 offset:20480
    ds_read_b64_tr_b16 v[202:203], v10 offset:22528
    ds_read_b64_tr_b16 v[204:205], v11 offset:20480
    ds_read_b64_tr_b16 v[206:207], v11 offset:22528
    s_waitcnt lgkmcnt(14)
    v_mfma_f32_32x32x16_bf16 v[112:127], v[176:179], v[48:51], 0
    s_waitcnt lgkmcnt(12)
    v_mfma_f32_32x32x16_bf16 v[128:143], v[180:183], v[48:51], 0
    s_waitcnt lgkmcnt(10)
    v_mfma_f32_32x32x16_bf16 v[144:159], v[184:187], v[48:51], 0
    s_waitcnt lgkmcnt(8)
    v_mfma_f32_32x32x16_bf16 v[160:175], v[188:191], v[48:51], 0
    s_waitcnt lgkmcnt(6)
    v_mfma_f32_32x32x16_bf16 v[112:127], v[192:195], v[52:55], v[112:127]
    s_waitcnt lgkmcnt(4)
    v_mfma_f32_32x32x16_bf16 v[128:143], v[196:199], v[52:55], v[128:143]
    s_waitcnt lgkmcnt(2)
    v_mfma_f32_32x32x16_bf16 v[144:159], v[200:203], v[52:55], v[144:159]
    s_waitcnt lgkmcnt(0)
    v_mfma_f32_32x32x16_bf16 v[160:175], v[204:207], v[52:55], v[160:175]
    v_mov_b32 v3, 9
    ds_write_b32 v4, v3 offset:16
    s_cmp_ge_u32 s45, s57
    s_cbranch_scc1 Lo_42
    s_mov_b32 s40, 0
Lw_41:
    ds_read_b32 v3, v7 offset:0
    s_add_u32 s40, s40, 1
    s_waitcnt lgkmcnt(0)
    v_readfirstlane_b32 s45, v3
    s_cmp_ge_u32 s45, s57
    s_cbranch_scc1 Lo_42
    s_sleep 1
    s_cmp_lt_u32 s40, 0x400000
    s_cbranch_scc1 Lw_41
Lo_42:
    s_add_u32 s57, s57, 4
    ds_read_b64_tr_b16 v[208:209], v8 offset:0
    ds_read_b64_tr_b16 v[210:211], v8 offset:2048
    ds_read_b64_tr_b16 v[212:213], v9 offset:0
    ds_read_b64_tr_b16 v[214:215], v9 offset:2048
    ds_read_b64_tr_b16 v[216:217], v10 offset:0
    ds_read_b64_tr_b16 v[218:219], v10 offset:2048
    ds_read_b64_tr_b16 v[220:221], v11 offset:0
    ds_read_b64_tr_b16 v[222:223], v11 offset:2048
    ds_read_b64_tr_b16 v[224:225], v8 offset:4096
    ds_read_b64_tr_b16 v[226:227], v8 offset:6144
    ds_read_b64_tr_b16 v[228:229], v9 offset:4096
    ds_read_b64_tr_b16 v[230:231], v9 offset:6144
    ds_read_b64_tr_b16 v[232:233], v10 offset:4096
    ds_read_b64_tr_b16 v[234:235], v10 offset:6144
    ds_read_b64_tr_b16 v[236:237], v11 offset:4096
    ds_read_b64_tr_b16 v[238:239], v11 offset:6144
    s_waitcnt lgkmcnt(14)
    v_mfma_f32_32x32x16_bf16 v[112:127], v[208:211], v[56:59], v[112:127]
    s_waitcnt lgkmcnt(12)
    v_mfma_f32_32x32x16_bf16 v[128:143], v[212:215], v[56:59], v[128:143]
    s_waitcnt lgkmcnt(10)
    v_mfma_f32_32x32x16_bf16 v[144:159], v[216:219], v[56:59], v[144:159]
    s_waitcnt lgkmcnt(8)
    v_mfma_f32_32x32x16_bf16 v[160:175], v[220:223], v[56:59], v[160:175]
    s_waitcnt lgkmcnt(6)
    v_mfma_f32_32x32x16_bf16 v[112:127], v[224:227], v[60:63], v[112:127]
    s_waitcnt lgkmcnt(4)
    v_mfma_f32_32x32x16_bf16 v[128:143], v[228:231], v[60:63], v[128:143]
    s_waitcnt lgkmcnt(2)
    v_mfma_f32_32x32x16_bf16 v[144:159], v[232:235], v[60:63], v[144:159]
    s_waitcnt lgkmcnt(0)
    v_mfma_f32_32x32x16_bf16 v[160:175], v[236:239], v[60:63], v[160:175]
    v_mov_b32 v3, 10
    ds_write_b32 v4, v3 offset:16
    s_cmp_ge_u32 s45, s57
    s_cbranch_scc1 Lo_44
    s_mov_b32 s40, 0
Lw_43:
    ds_read_b32 v3, v7 offset:0
    s_add_u32 s40, s40, 1
    s_waitcnt lgkmcnt(0)
    v_readfirstlane_b32 s45, v3
    s_cmp_ge_u32 s45, s57
    s_cbranch_scc1 Lo_44
    s_sleep 1
    s_cmp_lt_u32 s40, 0x400000
    s_cbranch_scc1 Lw_43
Lo_44:
    s_add_u32 s57, s57, 4
    ds_read_b64_tr_b16 v[176:177], v8 offset:8192
    ds_read_b64_tr_b16 v[178:179], v8 offset:10240
    ds_read_b64_tr_b16 v[180:181], v9 offset:8192
    ds_read_b64_tr_b16 v[182:183], v9 offset:10240
    ds_read_b64_tr_b16 v[184:185], v10 offset:8192
    ds_read_b64_tr_b16 v[186:187], v10 offset:10240
    ds_read_b64_tr_b16 v[188:189], v11 offset:8192
    ds_read_b64_tr_b16 v[190:191], v11 offset:10240
    ds_read_b64_tr_b16 v[192:193], v8 offset:12288
    ds_read_b64_tr_b16 v[194:195], v8 offset:14336
    ds_read_b64_tr_b16 v[196:197], v9 offset:12288
    ds_read_b64_tr_b16 v[198:199], v9 offset:14336
    ds_read_b64_tr_b16 v[200:201], v10 offset:12288
    ds_read_b64_tr_b16 v[202:203], v10 offset:14336
    ds_read_b64_tr_b16 v[204:205], v11 offset:12288
    ds_read_b64_tr_b16 v[206:207], v11 offset:14336
    s_waitcnt lgkmcnt(14)
    v_mfma_f32_32x32x16_bf16 v[112:127], v[176:179], v[64:67], v[112:127]
    s_waitcnt lgkmcnt(12)
    v_mfma_f32_32x32x16_bf16 v[128:143], v[180:183], v[64:67], v[128:143]
    s_waitcnt lgkmcnt(10)
    v_mfma_f32_32x32x16_bf16 v[144:159], v[184:187], v[64:67], v[144:159]
    s_waitcnt lgkmcnt(8)
    v_mfma_f32_32x32x16_bf16 v[160:175], v[188:191], v[64:67], v[160:175]
    s_waitcnt lgkmcnt(6)
    v_mfma_f32_32x32x16_bf16 v[112:127], v[192:195], v[68:71], v[112:127]
    s_waitcnt lgkmcnt(4)
    v_mfma_f32_32x32x16_bf16 v[128:143], v[196:199], v[68:71], v[128:143]
    s_waitcnt lgkmcnt(2)
    v_mfma_f32_32x32x16_bf16 v[144:159], v[200:203], v[68:71], v[144:159]
    s_waitcnt lgkmcnt(0)
    v_mfma_f32_32x32x16_bf16 v[160:175], v[204:207], v[68:71], v[160:175]
    v_mov_b32 v3, 11
    ds_write_b32 v4, v3 offset:16
    s_cmp_ge_u32 s45, s57
    s_cbranch_scc1 Lo_46
    s_mov_b32 s40, 0
Lw_45:
    ds_read_b32 v3, v7 offset:0
    s_add_u32 s40, s40, 1
    s_waitcnt lgkmcnt(0)
    v_readfirstlane_b32 s45, v3
    s_cmp_ge_u32 s45, s57
    s_cbranch_scc1 Lo_46
    s_sleep 1
    s_cmp_lt_u32 s40, 0x400000
    s_cbranch_scc1 Lw_45
Lo_46:
    s_add_u32 s57, s57, 4
    ds_read_b64_tr_b16 v[208:209], v8 offset:16384
    ds_read_b64_tr_b16 v[210:211], v8 offset:18432
    ds_read_b64_tr_b16 v[212:213], v9 offset:16384
    ds_read_b64_tr_b16 v[214:215], v9 offset:18432
    ds_read_b64_tr_b16 v[216:217], v10 offset:16384
    ds_read_b64_tr_b16 v[218:219], v10 offset:18432
    ds_read_b64_tr_b16 v[220:221], v11 offset:16384
    ds_read_b64_tr_b16 v[222:223], v11 offset:18432
    ds_read_b64_tr_b16 v[224:225], v8 offset:20480
    ds_read_b64_tr_b16 v[226:227], v8 offset:22528
    ds_read_b64_tr_b16 v[228:229], v9 offset:20480
    ds_read_b64_tr_b16 v[230:231], v9 offset:22528
    ds_read_b64_tr_b16 v[232:233], v10 offset:20480
    ds_read_b64_tr_b16 v[234:235], v10 offset:22528
    ds_read_b64_tr_b16 v[236:237], v11 offset:20480
    ds_read_b64_tr_b16 v[238:239], v11 offset:22528
    s_waitcnt lgkmcnt(14)
    v_mfma_f32_32x32x16_bf16 v[112:127], v[208:211], v[72:75], v[112:127]
    s_waitcnt lgkmcnt(12)
    v_mfma_f32_32x32x16_bf16 v[128:143], v[212:215], v[72:75], v[128:143]
    s_waitcnt lgkmcnt(10)
    v_mfma_f32_32x32x16_bf16 v[144:159], v[216:219], v[72:75], v[144:159]
    s_waitcnt lgkmcnt(8)
    v_mfma_f32_32x32x16_bf16 v[160:175], v[220:223], v[72:75], v[160:175]
    s_waitcnt lgkmcnt(6)
    v_mfma_f32_32x32x16_bf16 v[112:127], v[224:227], v[76:79], v[112:127]
    s_waitcnt lgkmcnt(4)
    v_mfma_f32_32x32x16_bf16 v[128:143], v[228:231], v[76:79], v[128:143]
    s_waitcnt lgkmcnt(2)
    v_mfma_f32_32x32x16_bf16 v[144:159], v[232:235], v[76:79], v[144:159]
    s_waitcnt lgkmcnt(0)
    v_mfma_f32_32x32x16_bf16 v[160:175], v[236:239], v[76:79], v[160:175]
    v_mov_b32 v3, 12
    ds_write_b32 v4, v3 offset:16
    s_cmp_ge_u32 s45, s57
    s_cbranch_scc1 Lo_48
    s_mov_b32 s40, 0
Lw_47:
    ds_read_b32 v3, v7 offset:0
    s_add_u32 s40, s40, 1
    s_waitcnt lgkmcnt(0)
    v_readfirstlane_b32 s45, v3
    s_cmp_ge_u32 s45, s57
    s_cbranch_scc1 Lo_48
    s_sleep 1
    s_cmp_lt_u32 s40, 0x400000
    s_cbranch_scc1 Lw_47
Lo_48:
    s_add_u32 s57, s57, 4
    ds_read_b64_tr_b16 v[176:177], v8 offset:0
    ds_read_b64_tr_b16 v[178:179], v8 offset:2048
    ds_read_b64_tr_b16 v[180:181], v9 offset:0
    ds_read_b64_tr_b16 v[182:183], v9 offset:2048
    ds_read_b64_tr_b16 v[184:185], v10 offset:0
    ds_read_b64_tr_b16 v[186:187], v10 offset:2048
    ds_read_b64_tr_b16 v[188:189], v11 offset:0
    ds_read_b64_tr_b16 v[190:191], v11 offset:2048
    ds_read_b64_tr_b16 v[192:193], v8 offset:4096
    ds_read_b64_tr_b16 v[194:195], v8 offset:6144
    ds_read_b64_tr_b16 v[196:197], v9 offset:4096
    ds_read_b64_tr_b16 v[198:199], v9 offset:6144
    ds_read_b64_tr_b16 v[200:201], v10 offset:4096
    ds_read_b64_tr_b16 v[202:203], v10 offset:6144
    ds_read_b64_tr_b16 v[204:205], v11 offset:4096
    ds_read_b64_tr_b16 v[206:207], v11 offset:6144
    s_waitcnt lgkmcnt(14)
    v_mfma_f32_32x32x16_bf16 v[112:127], v[176:179], v[80:83], v[112:127]
    s_waitcnt lgkmcnt(12)
    v_mfma_f32_32x32x16_bf16 v[128:143], v[180:183], v[80:83], v[128:143]
    s_waitcnt lgkmcnt(10)
    v_mfma_f32_32x32x16_bf16 v[144:159], v[184:187], v[80:83], v[144:159]
    s_waitcnt lgkmcnt(8)
    v_mfma_f32_32x32x16_bf16 v[160:175], v[188:191], v[80:83], v[160:175]
    s_waitcnt lgkmcnt(6)
    v_mfma_f32_32x32x16_bf16 v[112:127], v[192:195], v[84:87], v[112:127]
    s_waitcnt lgkmcnt(4)
    v_mfma_f32_32x32x16_bf16 v[128:143], v[196:199], v[84:87], v[128:143]
    s_waitcnt lgkmcnt(2)
    v_mfma_f32_32x32x16_bf16 v[144:159], v[200:203], v[84:87], v[144:159]
    s_waitcnt lgkmcnt(0)
    v_mfma_f32_32x32x16_bf16 v[160:175], v[204:207], v[84:87], v[160:175]
    v_mov_b32 v3, 13
    ds_write_b32 v4, v3 offset:16
    s_mov_b32 s40, 0
Lw_49:
    ds_read_b32 v3, v7 offset:32
    s_add_u32 s40, s40, 1
    s_waitcnt lgkmcnt(0)
    v_readfirstlane_b32 s7, v3
    s_cmp_ge_u32 s7, 1
    s_cbranch_scc1 Lo_50
    s_sleep 1
    s_cmp_lt_u32 s40, 0x400000
    s_cbranch_scc1 Lw_49
Lo_50:
    v_and_b32 v6, 31, v0
    v_lshlrev_b32 v20, 4, v6
    s_lshl_b32 s7, s44, 2
    s_add_u32 s7, s7, 0x26400
    v_add_u32 v20, s7, v20
    v_xor_b32 v21, 4, v20
    v_xor_b32 v22, 8, v20
    v_xor_b32 v23, 12, v20
    ds_read_b32 v16, v20
    ds_read_b32 v17, v21
    ds_read_b32 v18, v22
    ds_read_b32 v19, v23
    s_xor_b32 s7, s44, 1
    s_mul_i32 s7, s7, 24576
    v_add_u32 v12, s7, v5
    s_xor_b32 s7, s44, 2
    s_mul_i32 s7, s7, 24576
    v_add_u32 v13, s7, v5
    s_xor_b32 s7, s44, 3
    s_mul_i32 s7, s7, 24576
    v_add_u32 v14, s7, v5
    v_add_u32 v24, s38, v5
    v_lshrrev_b32 v6, 2, v6
    v_lshlrev_b32 v6, 13, v6
    v_lshrrev_b32 v20, 5, v0
    v_lshl_add_u32 v6, v20, 6, v6
    v_and_b32 v20, 3, v0
    v_lshl_add_u32 v6, v20, 4, v6
    v_mov_b32 v15, s13
    s_andn2_b32 s37, s4, 7
    s_lshl_b32 s37, s37, 13
    s_and_b32 s7, s4, 7
    s_lshl_b32 s7, s7, 10
    s_add_u32 s37, s37, s7
    s_lshl_b32 s7, s44, 8
    s_add_u32 s37, s37, s7
    s_add_u32 s37, s37, 0x200000
    s_waitcnt lgkmcnt(0)
    v_mul_f32 v240, v240, v16
    v_mul_f32 v241, v241, v16
    v_mul_f32 v242, v242, v16
    v_mul_f32 v243, v243, v16
    v_mul_f32 v244, v244, v16
    v_mul_f32 v245, v245, v16
    v_mul_f32 v246, v246, v16
    v_mul_f32 v247, v247, v16
    v_mul_f32 v248, v248, v16
    v_mul_f32 v249, v249, v16
    v_mul_f32 v250, v250, v16
    v_mul_f32 v251, v251, v16
    v_mul_f32 v252, v252, v16
    v_mul_f32 v253, v253, v16
    v_mul_f32 v254, v254, v16
    v_mul_f32 v255, v255, v16
    v_cvt_pk_bf16_f32 v240, v240, v241
    v_cvt_pk_bf16_f32 v241, v242, v243
    v_cvt_pk_bf16_f32 v242, v244, v245
    v_cvt_pk_bf16_f32 v243, v246, v247
    v_cvt_pk_bf16_f32 v244, v248, v249
    v_cvt_pk_bf16_f32 v245, v250, v251
    v_cvt_pk_bf16_f32 v246, v252, v253
    v_cvt_pk_bf16_f32 v247, v254, v255
    s_lshl_b32 s7, s44, 11
    v_add_u32 v25, 0x24000, v5
    v_add_u32 v20, s7, v25
    ds_write_b128 v20, v[240:243]
    ds_write_b128 v20, v[244:247] offset:1024
    v_subrev_u32 v26, s38, v8
    v_add_u32 v27, 0xc000, v26
    s_cmp_ge_u32 s45, s57
    s_cbranch_scc1 Lo_52
    s_mov_b32 s40, 0
Lw_51:
    ds_read_b32 v3, v7 offset:0
    s_add_u32 s40, s40, 1
    s_waitcnt lgkmcnt(0)
    v_readfirstlane_b32 s45, v3
    s_cmp_ge_u32 s45, s57
    s_cbranch_scc1 Lo_52
    s_sleep 1
    s_cmp_lt_u32 s40, 0x400000
    s_cbranch_scc1 Lw_51
Lo_52:
    s_add_u32 s57, s57, 4
    ds_read_b64_tr_b16 v[208:209], v8 offset:8192
    ds_read_b64_tr_b16 v[210:211], v8 offset:10240
    ds_read_b64_tr_b16 v[212:213], v9 offset:8192
    ds_read_b64_tr_b16 v[214:215], v9 offset:10240
    ds_read_b64_tr_b16 v[216:217], v10 offset:8192
    ds_read_b64_tr_b16 v[218:219], v10 offset:10240
    ds_read_b64_tr_b16 v[220:221], v11 offset:8192
    ds_read_b64_tr_b16 v[222:223], v11 offset:10240
    ds_read_b64_tr_b16 v[224:225], v8 offset:12288
    ds_read_b64_tr_b16 v[226:227], v8 offset:14336
    ds_read_b64_tr_b16 v[228:229], v9 offset:12288
    ds_read_b64_tr_b16 v[230:231], v9 offset:14336
    ds_read_b64_tr_b16 v[232:233], v10 offset:12288
    ds_read_b64_tr_b16 v[234:235], v10 offset:14336
    ds_read_b64_tr_b16 v[236:237], v11 offset:12288
    ds_read_b64_tr_b16 v[238:239], v11 offset:14336
    s_waitcnt lgkmcnt(14)
    v_mfma_f32_32x32x16_bf16 v[112:127], v[208:211], v[88:91], v[112:127]
    s_waitcnt lgkmcnt(12)
    v_mfma_f32_32x32x16_bf16 v[128:143], v[212:215], v[88:91], v[128:143]
    s_waitcnt lgkmcnt(10)
    v_mfma_f32_32x32x16_bf16 v[144:159], v[216:219], v[88:91], v[144:159]
    s_waitcnt lgkmcnt(8)
    v_mfma_f32_32x32x16_bf16 v[160:175], v[220:223], v[88:91], v[160:175]
    s_waitcnt lgkmcnt(6)
    v_mfma_f32_32x32x16_bf16 v[112:127], v[224:227], v[92:95], v[112:127]
    s_waitcnt lgkmcnt(4)
    v_mfma_f32_32x32x16_bf16 v[128:143], v[228:231], v[92:95], v[128:143]
    s_waitcnt lgkmcnt(2)
    v_mfma_f32_32x32x16_bf16 v[144:159], v[232:235], v[92:95], v[144:159]
    s_waitcnt lgkmcnt(0)
    v_mfma_f32_32x32x16_bf16 v[160:175], v[236:239], v[92:95], v[160:175]
L_tailcode:
    s_cmp_ge_u32 s45, s57
    s_cbranch_scc1 Lo_54
    s_mov_b32 s40, 0
Lw_53:
    ds_read_b32 v3, v7 offset:0
    s_add_u32 s40, s40, 1
    s_waitcnt lgkmcnt(0)
    v_readfirstlane_b32 s45, v3
    s_cmp_ge_u32 s45, s57
    s_cbranch_scc1 Lo_54
    s_cmp_lt_u32 s40, 0x400000
    s_cbranch_scc1 Lw_53
Lo_54:
    s_add_u32 s57, s57, 4
    ds_read_b64_tr_b16 v[180:181], v9 offset:16384
    ds_read_b64_tr_b16 v[182:183], v9 offset:18432
    ds_read_b64_tr_b16 v[196:197], v9 offset:20480
    ds_read_b64_tr_b16 v[198:199], v9 offset:22528
    ds_read_b64_tr_b16 v[184:185], v10 offset:16384
    ds_read_b64_tr_b16 v[186:187], v10 offset:18432
    ds_read_b64_tr_b16 v[200:201], v10 offset:20480
    ds_read_b64_tr_b16 v[202:203], v10 offset:22528
    ds_read_b64_tr_b16 v[188:189], v11 offset:16384
    ds_read_b64_tr_b16 v[190:191], v11 offset:18432
    ds_read_b64_tr_b16 v[204:205], v11 offset:20480
    ds_read_b64_tr_b16 v[206:207], v11 offset:22528
    ds_read_b64_tr_b16 v[176:177], v8 offset:16384
    ds_read_b64_tr_b16 v[178:179], v8 offset:18432
    ds_read_b64_tr_b16 v[192:193], v8 offset:20480
    ds_read_b64_tr_b16 v[194:195], v8 offset:22528
    s_waitcnt lgkmcnt(14)
    v_mfma_f32_32x32x16_bf16 v[128:143], v[180:183], v[96:99], v[128:143]
    s_waitcnt lgkmcnt(12)
    v_mfma_f32_32x32x16_bf16 v[128:143], v[196:199], v[100:103], v[128:143]
    s_waitcnt lgkmcnt(10)
    v_mfma_f32_32x32x16_bf16 v[144:159], v[184:187], v[96:99], v[144:159]
    s_waitcnt lgkmcnt(8)
    v_mfma_f32_32x32x16_bf16 v[144:159], v[200:203], v[100:103], v[144:159]
    s_waitcnt lgkmcnt(6)
    v_mfma_f32_32x32x16_bf16 v[160:175], v[188:191], v[96:99], v[160:175]
    s_waitcnt lgkmcnt(4)
    v_mfma_f32_32x32x16_bf16 v[160:175], v[204:207], v[100:103], v[160:175]
    s_waitcnt lgkmcnt(2)
    v_mfma_f32_32x32x16_bf16 v[112:127], v[176:179], v[96:99], v[112:127]
    s_waitcnt lgkmcnt(0)
    v_mfma_f32_32x32x16_bf16 v[112:127], v[192:195], v[100:103], v[112:127]
    ds_write_b128 v24, v[128:131] offset:8192
    ds_write_b128 v24, v[132:135] offset:9216
    ds_write_b128 v24, v[136:139] offset:10240
    ds_write_b128 v24, v[140:143] offset:11264
    ds_write_b128 v24, v[144:147] offset:12288
    ds_write_b128 v24, v[148:151] offset:13312
    ds_write_b128 v24, v[152:155] offset:14336
    ds_write_b128 v24, v[156:159] offset:15360
    ds_write_b128 v24, v[160:163] offset:16384
    ds_write_b128 v24, v[164:167] offset:17408
    ds_write_b128 v24, v[168:171] offset:18432
    ds_write_b128 v24, v[172:175] offset:19456
    s_waitcnt lgkmcnt(0)
    s_mov_b64 exec, 1
    v_mov_b32 v3, 1
    ds_add_u32 v7, v3 offset:12
    s_mov_b64 exec, -1
    v_mul_f32 v112, v112, v16
    v_mul_f32 v113, v113, v16
    v_mul_f32 v114, v114, v16
    v_mul_f32 v115, v115, v16
    v_mul_f32 v116, v116, v16
    v_mul_f32 v117, v117, v16
    v_mul_f32 v118, v118, v16
    v_mul_f32 v119, v119, v16
    v_mul_f32 v120, v120, v16
    v_mul_f32 v121, v121, v16
    v_mul_f32 v122, v122, v16
    v_mul_f32 v123, v123, v16
    v_mul_f32 v124, v124, v16
    v_mul_f32 v125, v125, v16
    v_mul_f32 v126, v126, v16
    v_mul_f32 v127, v127, v16
    s_mov_b32 s40, 0
Lw_55:
    ds_read_b32 v3, v7 offset:12
    s_add_u32 s40, s40, 1
    s_waitcnt lgkmcnt(0)
    v_readfirstlane_b32 s7, v3
    s_cmp_ge_u32 s7, 4
    s_cbranch_scc1 Lo_56
    s_cmp_lt_u32 s40, 0x400000
    s_cbranch_scc1 Lw_55
Lo_56:
    ds_read_b128 v[128:131], v12 offset:8192
    ds_read_b128 v[144:147], v13 offset:12288
    ds_read_b128 v[160:163], v14 offset:16384
    ds_read_b128 v[132:135], v12 offset:9216
    ds_read_b128 v[148:151], v13 offset:13312
    ds_read_b128 v[164:167], v14 offset:17408
    ds_read_b128 v[136:139], v12 offset:10240
    ds_read_b128 v[152:155], v13 offset:14336
    ds_read_b128 v[168:171], v14 offset:18432
    ds_read_b128 v[140:143], v12 offset:11264
    ds_read_b128 v[156:159], v13 offset:15360
    ds_read_b128 v[172:175], v14 offset:19456
    s_waitcnt lgkmcnt(9)
    v_fmac_f32 v112, v128, v17
    v_fmac_f32 v113, v129, v17
    v_fmac_f32 v114, v130, v17
    v_fmac_f32 v115, v131, v17
    v_fmac_f32 v112, v144, v18
    v_fmac_f32 v113, v145, v18
    v_fmac_f32 v114, v146, v18
    v_fmac_f32 v115, v147, v18
    v_fmac_f32 v112, v160, v19
    v_fmac_f32 v113, v161, v19
    v_fmac_f32 v114, v162, v19
    v_fmac_f32 v115, v163, v19
    s_waitcnt lgkmcnt(6)
    v_fmac_f32 v116, v132, v17
    v_fmac_f32 v117, v133, v17
    v_fmac_f32 v118, v134, v17
    v_fmac_f32 v119, v135, v17
    v_fmac_f32 v116, v148, v18
    v_fmac_f32 v117, v149, v18
    v_fmac_f32 v118, v150, v18
    v_fmac_f32 v119, v151, v18
    v_fmac_f32 v116, v164, v19
    v_fmac_f32 v117, v165, v19
    v_fmac_f32 v118, v166, v19
    v_fmac_f32 v119, v167, v19
    s_waitcnt lgkmcnt(3)
    v_fmac_f32 v120, v136, v17
    v_fmac_f32 v121, v137, v17
    v_fmac_f32 v122, v138, v17
    v_fmac_f32 v123, v139, v17
    v_fmac_f32 v120, v152, v18
    v_fmac_f32 v121, v153, v18
    v_fmac_f32 v122, v154, v18
    v_fmac_f32 v123, v155, v18
    v_fmac_f32 v120, v168, v19
    v_fmac_f32 v121, v169, v19
    v_fmac_f32 v122, v170, v19
    v_fmac_f32 v123, v171, v19
    s_waitcnt lgkmcnt(0)
    v_fmac_f32 v124, v140, v17
    v_fmac_f32 v125, v141, v17
    v_fmac_f32 v126, v142, v17
    v_fmac_f32 v127, v143, v17
    v_fmac_f32 v124, v156, v18
    v_fmac_f32 v125, v157, v18
    v_fmac_f32 v126, v158, v18
    v_fmac_f32 v127, v159, v18
    v_fmac_f32 v124, v172, v19
    v_fmac_f32 v125, v173, v19
    v_fmac_f32 v126, v174, v19
    v_fmac_f32 v127, v175, v19
    ds_read_b128 v[48:51], v25 offset:0
    ds_read_b128 v[52:55], v25 offset:1024
    ds_read_b128 v[56:59], v25 offset:2048
    ds_read_b128 v[60:63], v25 offset:3072
    ds_read_b128 v[64:67], v25 offset:4096
    ds_read_b128 v[68:71], v25 offset:5120
    ds_read_b128 v[72:75], v25 offset:6144
    ds_read_b128 v[76:79], v25 offset:7168
    s_cmp_ge_u32 s45, 61
    s_cbranch_scc1 Lo_58
    s_mov_b32 s40, 0
Lw_57:
    ds_read_b32 v3, v7 offset:0
    s_add_u32 s40, s40, 1
    s_waitcnt lgkmcnt(0)
    v_readfirstlane_b32 s45, v3
    s_cmp_ge_u32 s45, 61
    s_cbranch_scc1 Lo_58
    s_cmp_lt_u32 s40, 0x400000
    s_cbranch_scc1 Lw_57
Lo_58:
    ds_read_b64_tr_b16 v[176:177], v26 offset:0
    ds_read_b64_tr_b16 v[178:179], v26 offset:2048
    ds_read_b64_tr_b16 v[180:181], v26 offset:4096
    ds_read_b64_tr_b16 v[182:183], v26 offset:6144
    s_waitcnt lgkmcnt(2)
    v_mfma_f32_32x32x16_bf16 v[112:127], v[176:179], v[48:51], v[112:127]
    s_waitcnt lgkmcnt(0)
    v_mfma_f32_32x32x16_bf16 v[112:127], v[180:183], v[52:55], v[112:127]
    s_cmp_ge_u32 s45, 62
    s_cbranch_scc1 Lo_60
    s_mov_b32 s40, 0
Lw_59:
    ds_read_b32 v3, v7 offset:0
    s_add_u32 s40, s40, 1
    s_waitcnt lgkmcnt(0)
    v_readfirstlane_b32 s45, v3
    s_cmp_ge_u32 s45, 62
    s_cbranch_scc1 Lo_60
    s_cmp_lt_u32 s40, 0x400000
    s_cbranch_scc1 Lw_59
Lo_60:
    ds_read_b64_tr_b16 v[184:185], v26 offset:24576
    ds_read_b64_tr_b16 v[186:187], v26 offset:26624
    ds_read_b64_tr_b16 v[188:189], v26 offset:28672
    ds_read_b64_tr_b16 v[190:191], v26 offset:30720
    s_waitcnt lgkmcnt(2)
    v_mfma_f32_32x32x16_bf16 v[112:127], v[184:187], v[56:59], v[112:127]
    s_waitcnt lgkmcnt(0)
    v_mfma_f32_32x32x16_bf16 v[112:127], v[188:191], v[60:63], v[112:127]
    s_cmp_ge_u32 s45, 63
    s_cbranch_scc1 Lo_62
    s_mov_b32 s40, 0
Lw_61:
    ds_read_b32 v3, v7 offset:0
    s_add_u32 s40, s40, 1
    s_waitcnt lgkmcnt(0)
    v_readfirstlane_b32 s45, v3
    s_cmp_ge_u32 s45, 63
    s_cbranch_scc1 Lo_62
    s_cmp_lt_u32 s40, 0x400000
    s_cbranch_scc1 Lw_61
Lo_62:
    ds_read_b64_tr_b16 v[192:193], v27 offset:0
    ds_read_b64_tr_b16 v[194:195], v27 offset:2048
    ds_read_b64_tr_b16 v[196:197], v27 offset:4096
    ds_read_b64_tr_b16 v[198:199], v27 offset:6144
    s_waitcnt lgkmcnt(2)
    v_mfma_f32_32x32x16_bf16 v[112:127], v[192:195], v[64:67], v[112:127]
    s_waitcnt lgkmcnt(0)
    v_mfma_f32_32x32x16_bf16 v[112:127], v[196:199], v[68:71], v[112:127]
    s_cmp_ge_u32 s45, 64
    s_cbranch_scc1 Lo_64
    s_mov_b32 s40, 0
Lw_63:
    ds_read_b32 v3, v7 offset:0
    s_add_u32 s40, s40, 1
    s_waitcnt lgkmcnt(0)
    v_readfirstlane_b32 s45, v3
    s_cmp_ge_u32 s45, 64
    s_cbranch_scc1 Lo_64
    s_cmp_lt_u32 s40, 0x400000
    s_cbranch_scc1 Lw_63
Lo_64:
    ds_read_b64_tr_b16 v[200:201], v27 offset:24576
    ds_read_b64_tr_b16 v[202:203], v27 offset:26624
    ds_read_b64_tr_b16 v[204:205], v27 offset:28672
    ds_read_b64_tr_b16 v[206:207], v27 offset:30720
    s_waitcnt lgkmcnt(2)
    v_mfma_f32_32x32x16_bf16 v[112:127], v[200:203], v[72:75], v[112:127]
    s_waitcnt lgkmcnt(0)
    v_mfma_f32_32x32x16_bf16 v[112:127], v[204:207], v[76:79], v[112:127]
    s_nop 7
    s_nop 3
    v_max3_f32 v20, |v112|, |v113|, |v114|
    v_max3_f32 v20, v20, |v115|, |v116|
    v_max3_f32 v20, v20, |v117|, |v118|
    v_max_f32_e64 v20, v20, |v119|
    v_lshrrev_b32 v20, 25, v20
    v_mad_i32_i24 v21, v20, -4, s14
    v_mul_u32_u24 v20, 0x2001, v20
    v_ldexp_f32 v112, v112, v21
    v_ldexp_f32 v113, v113, v21
    v_ldexp_f32 v114, v114, v21
    v_ldexp_f32 v115, v115, v21
    v_ldexp_f32 v116, v116, v21
    v_ldexp_f32 v117, v117, v21
    v_ldexp_f32 v118, v118, v21
    v_ldexp_f32 v119, v119, v21
    v_cvt_pkrtz_f16_f32 v32, v112, v113
    v_cvt_pkrtz_f16_f32 v33, v114, v115
    v_cvt_pkrtz_f16_f32 v34, v116, v117
    v_cvt_pkrtz_f16_f32 v35, v118, v119
    v_pk_add_u16 v32, v32, 4 op_sel_hi:[1,0]
    v_pk_add_u16 v33, v33, 4 op_sel_hi:[1,0]
    v_pk_add_u16 v34, v34, 4 op_sel_hi:[1,0]
    v_pk_add_u16 v35, v35, 4 op_sel_hi:[1,0]
    v_bfi_b32 v32, s12, v20, v32
    v_bfi_b32 v33, s12, v15, v33
    v_bfi_b32 v34, s12, v15, v34
    v_bfi_b32 v35, s12, v15, v35
    buffer_store_dwordx4 v[32:35], v6, s[28:31], s37 offen offset:0 sc1
    v_max3_f32 v20, |v120|, |v121|, |v122|
    v_max3_f32 v20, v20, |v123|, |v124|
    v_max3_f32 v20, v20, |v125|, |v126|
    v_max_f32_e64 v20, v20, |v127|
    v_lshrrev_b32 v20, 25, v20
    v_mad_i32_i24 v21, v20, -4, s14
    v_mul_u32_u24 v20, 0x2001, v20
    v_ldexp_f32 v120, v120, v21
    v_ldexp_f32 v121, v121, v21
    v_ldexp_f32 v122, v122, v21
    v_ldexp_f32 v123, v123, v21
    v_ldexp_f32 v124, v124, v21
    v_ldexp_f32 v125, v125, v21
    v_ldexp_f32 v126, v126, v21
    v_ldexp_f32 v127, v127, v21
    v_cvt_pkrtz_f16_f32 v36, v120, v121
    v_cvt_pkrtz_f16_f32 v37, v122, v123
    v_cvt_pkrtz_f16_f32 v38, v124, v125
    v_cvt_pkrtz_f16_f32 v39, v126, v127
    v_pk_add_u16 v36, v36, 4 op_sel_hi:[1,0]
    v_pk_add_u16 v37, v37, 4 op_sel_hi:[1,0]
    v_pk_add_u16 v38, v38, 4 op_sel_hi:[1,0]
    v_pk_add_u16 v39, v39, 4 op_sel_hi:[1,0]
    v_bfi_b32 v36, s12, v20, v36
    v_bfi_b32 v37, s12, v15, v37
    v_bfi_b32 v38, s12, v15, v38
    v_bfi_b32 v39, s12, v15, v39
    buffer_store_dwordx4 v[36:39], v6, s[28:31], s37 offen offset:128 sc1
L_T3:
    s_setprio 0
    v_lshrrev_b32 v13, 2, v0
    v_and_b32 v14, 3, v0
    v_lshlrev_b32 v5, 4, v0
    s_lshr_b32 s58, s4, 3
    s_lshl_b32 s37, s3, 5
    s_add_u32 s37, s37, s58
    s_lshl_b32 s37, s37, 13
    s_add_u32 s37, s37, 0x200000
    s_add_u32 s41, s37, 0x1000
    v_lshlrev_b32 v6, 8, v13
    v_lshl_add_u32 v6, v14, 4, v6
    s_lshr_b32 s7, s3, 2
    s_lshl_b32 s7, s7, 12
    s_and_b32 s36, s3, 3
    s_lshl_b32 s36, s36, 6
    s_add_u32 s7, s7, s36
    s_add_u32 s7, s7, 0x20000
    v_add_u32 v6, s7, v6
    v_add_u32 v10, 0x20000, v5
    v_bfe_u32 v9, v0, 2, 3
    v_lshrrev_b32 v8, 5, v0
    v_lshl_add_u32 v8, v8, 4, v9
    v_lshlrev_b32 v8, 8, v8
    v_lshl_add_u32 v8, v14, 3, v8
    v_lshl_add_u32 v8, v9, 5, v8
    s_lshl_b32 s7, s3, 5
    s_add_u32 s7, s7, 0x18000
    v_xor_b32 v8, s7, v8
    s_and_b32 s39, s4, 7
    s_lshl_b32 s44, s39, 8
    s_lshl_b32 s39, s39, 18
    s_add_u32 s39, s39, 0x400000
    s_lshl_b32 s7, s3, 10
    s_add_u32 s43, s39, s7
    s_lshl_b32 s7, s58, 13
    s_add_u32 s43, s43, s7
    s_lshl_b32 s7, s58, 8
    s_add_u32 s55, s39, s7
    s_lshl_b32 s7, s3, 6
    s_add_u32 s55, s55, s7
    s_add_u32 s56, s55, 0x20000
    s_lshl_b32 s7, s58, 3
    s_add_u32 s44, s44, s7
    s_lshl_b32 s7, s3, 13
    s_add_u32 s44, s44, s7
    v_and_b32 v9, 1, v1
    v_lshlrev_b32 v9, 2, v9
    v_and_b32 v3, 2, v1
    v_lshl_add_u32 v9, v3, 14, v9
    v_lshl_add_u32 v9, v14, 11, v9
    v_lshlrev_b32 v12, 13, v13
    v_lshl_add_u32 v12, v14, 4, v12
    v_mov_b32 v160, s13
    v_mov_b32 v161, 0x40020
    s_lshl_b32 s36, s3, 7
    s_add_u32 s36, s36, 0x26800
    v_lshl_add_u32 v4, v14, 5, s36
    s_mov_b32 s40, 0
Lw_65:
    ds_read_b32 v3, v7 offset:40
    s_add_u32 s40, s40, 1
    s_waitcnt lgkmcnt(0)
    v_readfirstlane_b32 s7, v3
    s_cmp_ge_u32 s7, 1
    s_cbranch_scc1 Lo_66
    s_sleep 1
    s_cmp_lt_u32 s40, 0x400000
    s_cbranch_scc1 Lw_65
Lo_66:
    ds_read_b128 v[96:99], v4
    ds_read_b128 v[100:103], v4 offset:16
    s_cmp_lg_u32 s3, 3
    s_cbranch_scc1 L_wow
    s_waitcnt vmcnt(0)
L_wgo:
    v_mov_b32 v3, 1
    ds_write_b32 v7, v3 offset:48
    s_waitcnt lgkmcnt(0)
    s_branch L_wok
L_wow:
    s_cmp_ge_u32 s45, 64
    s_cbranch_scc1 Lo_68
    s_mov_b32 s40, 0
Lw_67:
    ds_read_b32 v3, v7 offset:0
    s_add_u32 s40, s40, 1
    s_waitcnt lgkmcnt(0)
    v_readfirstlane_b32 s45, v3
    s_cmp_ge_u32 s45, 64
    s_cbranch_scc1 Lo_68
    s_sleep 1
    s_cmp_lt_u32 s40, 0x400000
    s_cbranch_scc1 Lw_67
Lo_68:
    s_mov_b32 s40, 0
Lw_69:
    ds_read_b32 v3, v7 offset:48
    s_add_u32 s40, s40, 1
    s_waitcnt lgkmcnt(0)
    v_readfirstlane_b32 s7, v3
    s_cmp_ge_u32 s7, 1
    s_cbranch_scc1 Lo_70
    s_cmp_lt_u32 s40, 0x400000
    s_cbranch_scc1 Lw_69
Lo_70:
L_wok:
    s_mov_b32 s40, 0
L_gath:
    buffer_load_dwordx4 v[64:67], v5, s[28:31], s37 offen offset:0 sc1
    buffer_load_dwordx4 v[68:71], v5, s[28:31], s37 offen offset:1024 sc1
    buffer_load_dwordx4 v[72:75], v5, s[28:31], s37 offen offset:2048 sc1
    buffer_load_dwordx4 v[76:79], v5, s[28:31], s37 offen offset:3072 sc1
    buffer_load_dwordx4 v[80:83], v5, s[28:31], s41 offen offset:0 sc1
    buffer_load_dwordx4 v[84:87], v5, s[28:31], s41 offen offset:1024 sc1
    buffer_load_dwordx4 v[88:91], v5, s[28:31], s41 offen offset:2048 sc1
    buffer_load_dwordx4 v[92:95], v5, s[28:31], s41 offen offset:3072 sc1
    ds_read_b64_tr_b16 v[128:129], v8 offset:0
    ds_read_b64_tr_b16 v[130:131], v8 offset:2048
    ds_read_b64_tr_b16 v[132:133], v8 offset:8192
    ds_read_b64_tr_b16 v[134:135], v8 offset:10240
    ds_read_b64_tr_b16 v[136:137], v8 offset:16384
    ds_read_b64_tr_b16 v[138:139], v8 offset:18432
    ds_read_b64_tr_b16 v[140:141], v8 offset:24576
    ds_read_b64_tr_b16 v[142:143], v8 offset:26624
    s_add_u32 s40, s40, 1
    s_waitcnt vmcnt(7)
    v_xor_b32 v65, s13, v65
    v_xor_b32 v66, s13, v66
    v_xor_b32 v67, s13, v67
    v_or3_b32 v4, v65, v66, v67
    v_and_b32 v104, s12, v64
    v_xor_b32 v64, v64, v104
    v_mad_u32_u24 v104, v104, v161, s15
    v_ashrrev_i32 v104, 16, v104
    v_ldexp_f32 v104, v96, v104
    v_fma_mix_f32 v16, v64, v104, 0 op_sel_hi:[1,0,0]
    v_fma_mix_f32 v17, v64, v104, 0 op_sel:[1,0,0] op_sel_hi:[1,0,0]
    v_fma_mix_f32 v18, v65, v104, 0 op_sel_hi:[1,0,0]
    v_fma_mix_f32 v19, v65, v104, 0 op_sel:[1,0,0] op_sel_hi:[1,0,0]
    v_fma_mix_f32 v20, v66, v104, 0 op_sel_hi:[1,0,0]
    v_fma_mix_f32 v21, v66, v104, 0 op_sel:[1,0,0] op_sel_hi:[1,0,0]
    v_fma_mix_f32 v22, v67, v104, 0 op_sel_hi:[1,0,0]
    v_fma_mix_f32 v23, v67, v104, 0 op_sel:[1,0,0] op_sel_hi:[1,0,0]
    s_waitcnt vmcnt(6)
    v_xor_b32 v69, s13, v69
    v_xor_b32 v70, s13, v70
    v_xor_b32 v71, s13, v71
    v_or3_b32 v4, v4, v69, v70
    v_and_b32 v105, s12, v68
    v_xor_b32 v68, v68, v105
    v_mad_u32_u24 v105, v105, v161, s15
    v_ashrrev_i32 v105, 16, v105
    v_ldexp_f32 v105, v97, v105
    v_fma_mix_f32 v16, v68, v105, v16 op_sel_hi:[1,0,0]
    v_fma_mix_f32 v17, v68, v105, v17 op_sel:[1,0,0] op_sel_hi:[1,0,0]
    v_fma_mix_f32 v18, v69, v105, v18 op_sel_hi:[1,0,0]
    v_fma_mix_f32 v19, v69, v105, v19 op_sel:[1,0,0] op_sel_hi:[1,0,0]
    v_fma_mix_f32 v20, v70, v105, v20 op_sel_hi:[1,0,0]
    v_fma_mix_f32 v21, v70, v105, v21 op_sel:[1,0,0] op_sel_hi:[1,0,0]
    v_fma_mix_f32 v22, v71, v105, v22 op_sel_hi:[1,0,0]
    v_fma_mix_f32 v23, v71, v105, v23 op_sel:[1,0,0] op_sel_hi:[1,0,0]
    s_waitcnt vmcnt(5)
    v_xor_b32 v73, s13, v73
    v_xor_b32 v74, s13, v74
    v_xor_b32 v75, s13, v75
    v_or3_b32 v4, v4, v71, v73
    v_or3_b32 v4, v4, v74, v75
    v_and_b32 v106, s12, v72
    v_xor_b32 v72, v72, v106
    v_mad_u32_u24 v106, v106, v161, s15
    v_ashrrev_i32 v106, 16, v106
    v_ldexp_f32 v106, v98, v106
    v_fma_mix_f32 v16, v72, v106, v16 op_sel_hi:[1,0,0]
    v_fma_mix_f32 v17, v72, v106, v17 op_sel:[1,0,0] op_sel_hi:[1,0,0]
    v_fma_mix_f32 v18, v73, v106, v18 op_sel_hi:[1,0,0]
    v_fma_mix_f32 v19, v73, v106, v19 op_sel:[1,0,0] op_sel_hi:[1,0,0]
    v_fma_mix_f32 v20, v74, v106, v20 op_sel_hi:[1,0,0]
    v_fma_mix_f32 v21, v74, v106, v21 op_sel:[1,0,0] op_sel_hi:[1,0,0]
    v_fma_mix_f32 v22, v75, v106, v22 op_sel_hi:[1,0,0]
    v_fma_mix_f32 v23, v75, v106, v23 op_sel:[1,0,0] op_sel_hi:[1,0,0]
    s_waitcnt vmcnt(4)
    v_xor_b32 v77, s13, v77
    v_xor_b32 v78, s13, v78
    v_xor_b32 v79, s13, v79
    v_or3_b32 v4, v4, v77, v78
    v_and_b32 v107, s12, v76
    v_xor_b32 v76, v76, v107
    v_mad_u32_u24 v107, v107, v161, s15
    v_ashrrev_i32 v107, 16, v107
    v_ldexp_f32 v107, v99, v107
    v_fma_mix_f32 v16, v76, v107, v16 op_sel_hi:[1,0,0]
    v_fma_mix_f32 v17, v76, v107, v17 op_sel:[1,0,0] op_sel_hi:[1,0,0]
    v_fma_mix_f32 v18, v77, v107, v18 op_sel_hi:[1,0,0]
    v_fma_mix_f32 v19, v77, v107, v19 op_sel:[1,0,0] op_sel_hi:[1,0,0]
    v_fma_mix_f32 v20, v78, v107, v20 op_sel_hi:[1,0,0]
    v_fma_mix_f32 v21, v78, v107, v21 op_sel:[1,0,0] op_sel_hi:[1,0,0]
    v_fma_mix_f32 v22, v79, v107, v22 op_sel_hi:[1,0,0]
    v_fma_mix_f32 v23, v79, v107, v23 op_sel:[1,0,0] op_sel_hi:[1,0,0]
    s_waitcnt vmcnt(3)
    v_xor_b32 v81, s13, v81
    v_xor_b32 v82, s13, v82
    v_xor_b32 v83, s13, v83
    v_or3_b32 v4, v4, v79, v81
    v_or3_b32 v4, v4, v82, v83
    v_and_b32 v108, s12, v80
    v_xor_b32 v80, v80, v108
    v_mad_u32_u24 v108, v108, v161, s15
    v_ashrrev_i32 v108, 16, v108
    v_ldexp_f32 v108, v100, v108
    v_fma_mix_f32 v16, v80, v108, v16 op_sel_hi:[1,0,0]
    v_fma_mix_f32 v17, v80, v108, v17 op_sel:[1,0,0] op_sel_hi:[1,0,0]
    v_fma_mix_f32 v18, v81, v108, v18 op_sel_hi:[1,0,0]
    v_fma_mix_f32 v19, v81, v108, v19 op_sel:[1,0,0] op_sel_hi:[1,0,0]
    v_fma_mix_f32 v20, v82, v108, v20 op_sel_hi:[1,0,0]
    v_fma_mix_f32 v21, v82, v108, v21 op_sel:[1,0,0] op_sel_hi:[1,0,0]
    v_fma_mix_f32 v22, v83, v108, v22 op_sel_hi:[1,0,0]
    v_fma_mix_f32 v23, v83, v108, v23 op_sel:[1,0,0] op_sel_hi:[1,0,0]
    s_waitcnt vmcnt(2)
    v_xor_b32 v85, s13, v85
    v_xor_b32 v86, s13, v86
    v_xor_b32 v87, s13, v87
    v_or3_b32 v4, v4, v85, v86
    v_and_b32 v109, s12, v84
    v_xor_b32 v84, v84, v109
    v_mad_u32_u24 v109, v109, v161, s15
    v_ashrrev_i32 v109, 16, v109
    v_ldexp_f32 v109, v101, v109
    v_fma_mix_f32 v16, v84, v109, v16 op_sel_hi:[1,0,0]
    v_fma_mix_f32 v17, v84, v109, v17 op_sel:[1,0,0] op_sel_hi:[1,0,0]
    v_fma_mix_f32 v18, v85, v109, v18 op_sel_hi:[1,0,0]
    v_fma_mix_f32 v19, v85, v109, v19 op_sel:[1,0,0] op_sel_hi:[1,0,0]
    v_fma_mix_f32 v20, v86, v109, v20 op_sel_hi:[1,0,0]
    v_fma_mix_f32 v21, v86, v109, v21 op_sel:[1,0,0] op_sel_hi:[1,0,0]
    v_fma_mix_f32 v22, v87, v109, v22 op_sel_hi:[1,0,0]
    v_fma_mix_f32 v23, v87, v109, v23 op_sel:[1,0,0] op_sel_hi:[1,0,0]
    s_waitcnt vmcnt(1)
    v_xor_b32 v89, s13, v89
    v_xor_b32 v90, s13, v90
    v_xor_b32 v91, s13, v91
    v_or3_b32 v4, v4, v87, v89
    v_or3_b32 v4, v4, v90, v91
    v_and_b32 v110, s12, v88
    v_xor_b32 v88, v88, v110
    v_mad_u32_u24 v110, v110, v161, s15
    v_ashrrev_i32 v110, 16, v110
    v_ldexp_f32 v110, v102, v110
    v_fma_mix_f32 v16, v88, v110, v16 op_sel_hi:[1,0,0]
    v_fma_mix_f32 v17, v88, v110, v17 op_sel:[1,0,0] op_sel_hi:[1,0,0]
    v_fma_mix_f32 v18, v89, v110, v18 op_sel_hi:[1,0,0]
    v_fma_mix_f32 v19, v89, v110, v19 op_sel:[1,0,0] op_sel_hi:[1,0,0]
    v_fma_mix_f32 v20, v90, v110, v20 op_sel_hi:[1,0,0]
    v_fma_mix_f32 v21, v90, v110, v21 op_sel:[1,0,0] op_sel_hi:[1,0,0]
    v_fma_mix_f32 v22, v91, v110, v22 op_sel_hi:[1,0,0]
    v_fma_mix_f32 v23, v91, v110, v23 op_sel:[1,0,0] op_sel_hi:[1,0,0]
    s_waitcnt vmcnt(0)
    v_xor_b32 v93, s13, v93
    v_xor_b32 v94, s13, v94
    v_xor_b32 v95, s13, v95
    v_or3_b32 v4, v4, v93, v94
    v_or_b32 v4, v4, v95
    v_and_b32 v111, s12, v92
    v_xor_b32 v92, v92, v111
    v_mad_u32_u24 v111, v111, v161, s15
    v_ashrrev_i32 v111, 16, v111
    v_ldexp_f32 v111, v103, v111
    v_fma_mix_f32 v16, v92, v111, v16 op_sel_hi:[1,0,0]
    v_fma_mix_f32 v17, v92, v111, v17 op_sel:[1,0,0] op_sel_hi:[1,0,0]
    v_fma_mix_f32 v18, v93, v111, v18 op_sel_hi:[1,0,0]
    v_fma_mix_f32 v19, v93, v111, v19 op_sel:[1,0,0] op_sel_hi:[1,0,0]
    v_fma_mix_f32 v20, v94, v111, v20 op_sel_hi:[1,0,0]
    v_fma_mix_f32 v21, v94, v111, v21 op_sel:[1,0,0] op_sel_hi:[1,0,0]
    v_fma_mix_f32 v22, v95, v111, v22 op_sel_hi:[1,0,0]
    v_fma_mix_f32 v23, v95, v111, v23 op_sel:[1,0,0] op_sel_hi:[1,0,0]
    v_and_b32 v4, s12, v4
    v_cmp_ne_u32 vcc, 0, v4
    s_cmp_ge_u32 s40, 40000
    s_cbranch_scc1 L_gdone
    s_cbranch_vccnz L_gath
L_gdone:
    v_cvt_pk_bf16_f32 v24, v16, v17
    v_cvt_pk_bf16_f32 v25, v18, v19
    v_cvt_pk_bf16_f32 v26, v20, v21
    v_cvt_pk_bf16_f32 v27, v22, v23
    ds_write_b128 v6, v[24:27]
    s_waitcnt lgkmcnt(0)
    s_barrier
    ds_read_b128 v[32:35], v10 offset:0
    ds_read_b128 v[36:39], v10 offset:4096
    ds_read_b128 v[40:43], v10 offset:1024
    ds_read_b128 v[44:47], v10 offset:5120
    ds_read_b128 v[48:51], v10 offset:2048
    ds_read_b128 v[52:55], v10 offset:6144
    ds_read_b128 v[56:59], v10 offset:3072
    ds_read_b128 v[60:63], v10 offset:7168
    s_waitcnt lgkmcnt(6)
    v_mfma_f32_16x16x32_bf16 v[16:19], v[128:131], v[32:35], 0
    v_mfma_f32_16x16x32_bf16 v[20:23], v[128:131], v[36:39], 0
    s_waitcnt lgkmcnt(4)
    v_mfma_f32_16x16x32_bf16 v[16:19], v[132:135], v[40:43], v[16:19]
    v_mfma_f32_16x16x32_bf16 v[20:23], v[132:135], v[44:47], v[20:23]
    s_waitcnt lgkmcnt(2)
    v_mfma_f32_16x16x32_bf16 v[16:19], v[136:139], v[48:51], v[16:19]
    v_mfma_f32_16x16x32_bf16 v[20:23], v[136:139], v[52:55], v[20:23]
    s_waitcnt lgkmcnt(0)
    v_mfma_f32_16x16x32_bf16 v[16:19], v[140:143], v[56:59], v[16:19]
    v_mfma_f32_16x16x32_bf16 v[20:23], v[140:143], v[60:63], v[20:23]
    s_nop 7
    v_max3_f32 v28, |v16|, |v17|, |v18|
    v_max3_f32 v28, v28, |v19|, |v20|
    v_max3_f32 v28, v28, |v21|, |v22|
    v_max_f32_e64 v28, v28, |v23|
    v_lshrrev_b32 v28, 25, v28
    v_mad_i32_i24 v29, v28, -4, s14
    v_mul_u32_u24 v28, 0x2001, v28
    v_ldexp_f32 v16, v16, v29
    v_ldexp_f32 v17, v17, v29
    v_ldexp_f32 v18, v18, v29
    v_ldexp_f32 v19, v19, v29
    v_ldexp_f32 v20, v20, v29
    v_ldexp_f32 v21, v21, v29
    v_ldexp_f32 v22, v22, v29
    v_ldexp_f32 v23, v23, v29
    v_cvt_pkrtz_f16_f32 v24, v16, v17
    v_cvt_pkrtz_f16_f32 v25, v18, v19
    v_cvt_pkrtz_f16_f32 v26, v20, v21
    v_cvt_pkrtz_f16_f32 v27, v22, v23
    v_pk_add_u16 v24, v24, 4 op_sel_hi:[1,0]
    v_pk_add_u16 v25, v25, 4 op_sel_hi:[1,0]
    v_pk_add_u16 v26, v26, 4 op_sel_hi:[1,0]
    v_pk_add_u16 v27, v27, 4 op_sel_hi:[1,0]
    v_bfi_b32 v24, s12, v28, v24
    v_bfi_b32 v25, s12, v160, v25
    v_bfi_b32 v26, s12, v160, v26
    v_bfi_b32 v27, s12, v160, v27
    buffer_store_dwordx4 v[24:27], v5, s[28:31], s43 offen sc1
    s_cmp_ge_u32 s3, 4
    s_cbranch_scc1 L_fin
    s_sleep 24
    s_mov_b32 s40, 0
    s_branch Lp_71
Lr_72:
    s_add_u32 s40, s40, 1
    s_cmp_ge_u32 s40, 40000
    s_cbranch_scc1 Lk_73
    s_sleep 2
Lp_71:
    buffer_load_dwordx4 v[64:67], v12, s[28:31], s55 offen sc1
    buffer_load_dwordx4 v[60:63], v12, s[28:31], s56 offen sc1
    s_waitcnt vmcnt(0)
    v_xor_b32 v65, s13, v65
    v_xor_b32 v66, s13, v66
    v_xor_b32 v67, s13, v67
    v_or3_b32 v7, v65, v66, v67
    v_xor_b32 v61, s13, v61
    v_xor_b32 v62, s13, v62
    v_xor_b32 v63, s13, v63
    v_or3_b32 v7, v7, v61, v62
    v_or_b32 v7, v7, v63
    v_and_b32 v7, s12, v7
    v_cmp_ne_u32 vcc, 0, v7
    s_cbranch_vccnz Lr_72
Lk_73:
    v_and_b32 v7, s12, v64
    v_xor_b32 v64, v64, v7
    v_mad_u32_u24 v7, v7, v161, s15
    v_ashrrev_i32 v7, 16, v7
    v_ldexp_f32 v7, 1.0, v7
    v_fma_mix_f32 v68, v64, v7, 0 op_sel_hi:[1,0,0]
    v_fma_mix_f32 v69, v64, v7, 0 op_sel:[1,0,0] op_sel_hi:[1,0,0]
    v_fma_mix_f32 v70, v65, v7, 0 op_sel_hi:[1,0,0]
    v_fma_mix_f32 v71, v65, v7, 0 op_sel:[1,0,0] op_sel_hi:[1,0,0]
    v_fma_mix_f32 v72, v66, v7, 0 op_sel_hi:[1,0,0]
    v_fma_mix_f32 v73, v66, v7, 0 op_sel:[1,0,0] op_sel_hi:[1,0,0]
    v_fma_mix_f32 v74, v67, v7, 0 op_sel_hi:[1,0,0]
    v_fma_mix_f32 v75, v67, v7, 0 op_sel:[1,0,0] op_sel_hi:[1,0,0]
    v_and_b32 v7, s12, v60
    v_xor_b32 v60, v60, v7
    v_mad_u32_u24 v7, v7, v161, s15
    v_ashrrev_i32 v7, 16, v7
    v_ldexp_f32 v7, 1.0, v7
    v_fma_mix_f32 v68, v60, v7, v68 op_sel_hi:[1,0,0]
    v_fma_mix_f32 v69, v60, v7, v69 op_sel:[1,0,0] op_sel_hi:[1,0,0]
    v_fma_mix_f32 v70, v61, v7, v70 op_sel_hi:[1,0,0]
    v_fma_mix_f32 v71, v61, v7, v71 op_sel:[1,0,0] op_sel_hi:[1,0,0]
    v_fma_mix_f32 v72, v62, v7, v72 op_sel_hi:[1,0,0]
    v_fma_mix_f32 v73, v62, v7, v73 op_sel:[1,0,0] op_sel_hi:[1,0,0]
    v_fma_mix_f32 v74, v63, v7, v74 op_sel_hi:[1,0,0]
    v_fma_mix_f32 v75, v63, v7, v75 op_sel:[1,0,0] op_sel_hi:[1,0,0]
    s_nop 0
    v_permlane32_swap_b32 v68, v72
    v_permlane32_swap_b32 v69, v73
    v_permlane32_swap_b32 v70, v74
    v_permlane32_swap_b32 v71, v75
    v_add_f32 v68, v68, v72
    v_add_f32 v69, v69, v73
    v_add_f32 v70, v70, v74
    v_add_f32 v71, v71, v75
    s_nop 0
    v_permlane16_swap_b32 v68, v70
    v_permlane16_swap_b32 v69, v71
    v_add_f32 v68, v68, v70
    v_add_f32 v69, v69, v71
    s_nop 0
    v_add_f32_dpp v68, v68, v68 row_ror:8 row_mask:0xf bank_mask:0xf
    v_add_f32_dpp v69, v69, v69 row_ror:8 row_mask:0xf bank_mask:0xf
    s_nop 0
    v_add_f32_dpp v68, v68, v68 row_ror:4 row_mask:0xf bank_mask:0xf
    v_add_f32_dpp v69, v69, v69 row_ror:4 row_mask:0xf bank_mask:0xf
    s_mov_b32 exec_lo, 0x000f000f
    s_mov_b32 exec_hi, 0x000f000f
    v_cvt_pk_bf16_f32 v64, v68, v69
    buffer_store_dword v64, v9, s[32:35], s44 offen sc0 sc1
    s_or_b32 s7, s4, s3
    s_cmp_lg_u32 s7, 0
    s_cbranch_scc1 L_fin
    s_mov_b64 exec, 1
    v_mov_b32 v66, s6
    buffer_store_dword v66, v5, s[28:31], 0 offen sc1
L_fin:
L_end:
    s_endpgm
.section .rodata,"a"
.p2align 6
.amdhsa_kernel standalone__gqa_block_cached__sampling_kernel
  .amdhsa_next_free_vgpr 256
  .amdhsa_next_free_sgpr 102
  .amdhsa_accum_offset 256
  .amdhsa_group_segment_fixed_size 0
  .amdhsa_kernarg_size 64
  .amdhsa_user_sgpr_count 2
  .amdhsa_user_sgpr_kernarg_segment_ptr 1
  .amdhsa_system_sgpr_workgroup_id_x 1
.end_amdhsa_kernel
```
